```python
import torch

def _softmax(x, axis=-1):
    return torch.softmax(x, dim=axis)
def _gelu(x):
    return torch.nn.functional.gelu(x, approximate="tanh")
def _silu(x):
    return torch.nn.functional.silu(x)
def _sigmoid(x):
    return torch.sigmoid(x)
def _layernorm(x, axis=-1, eps=1e-5):
    m = x.mean(dim=axis, keepdim=True)
    v = x.var(dim=axis, keepdim=True, unbiased=False)
    return (x - m) / torch.sqrt(v + eps)
def _scatter_add(tgt, idx, src, axis=0):
    return tgt.clone().index_add_(axis, idx, src)
def _segment_sum(src, seg, n):
    out = torch.zeros((n,) + src.shape[1:], dtype=src.dtype)
    return out.index_add_(0, seg, src)
def _pad(x, pw):
    flat = tuple(v for pair in reversed(pw) for v in pair)
    return torch.nn.functional.pad(x, flat)

kernel_name = 'standalone__gqa_block_cached__near_ridge'

def setup_inputs():

    _w = (lambda a: (lambda t: t.to(torch.bfloat16) if t.is_floating_point() else t)(torch.as_tensor(a)))
    B, Sq, D = 16, 32, 576
    Hq, Hkv, Sk, Dh = 32, 16, 32, 128
    assert Hq % Hkv == 0, (Hq, Hkv)
    return {
        "x": _w((lambda *s: torch.randn(*s, dtype=torch.bfloat16) * 0.8)(B, Sq, D)),
        "k_cache": _w((lambda *s: torch.randn(*s, dtype=torch.bfloat16) * 0.8)(B, Hkv, Sk, Dh)),
        "v_cache": _w((lambda *s: torch.randn(*s, dtype=torch.bfloat16) * 0.05)(B, Hkv, Sk, Dh)),
        "wq": _w((lambda *s: torch.randn(*s, dtype=torch.bfloat16) * 0.8)(D, Hq * Dh) * (D ** -0.5)),
        "wo": _w((lambda *s: torch.randn(*s, dtype=torch.bfloat16) * 0.05)(Hq * Dh, D) * ((Hq * Dh) ** -0.5)),
    }

def reference(x, k_cache, v_cache, wq, wo):
    B, Sq, D = x.shape
    Hq, Dh = 32, 128
    Hkv = k_cache.shape[1]
    rep = Hq // Hkv
    q = (lambda x, *d: x.permute(*d))((x @ wq).reshape(B, Sq, Hq, Dh), 0, 2, 1, 3)
    k = (lambda x, n, axis: torch.repeat_interleave(x, n, dim=axis))(k_cache, rep, axis=1)
    v = (lambda x, n, axis: torch.repeat_interleave(x, n, dim=axis))(v_cache, rep, axis=1)
    scores = torch.einsum("bhqd,bhkd->bhqk", q, k) * (Dh ** -0.5)
    p = _softmax(scores, axis=-1)
    o = torch.einsum("bhqk,bhkd->bhqd", p, v)
    return (lambda x, *d: x.permute(*d))(o, 0, 2, 1, 3).reshape(B, Sq, Hq * Dh) @ wo
```

```asm
; @launch grid=(256,1,1) block=(512,1,1) lds=163840
.amdgcn_target "amdgcn-amd-amdhsa--gfx950"
.text
.globl standalone__gqa_block_cached__near_ridge_kernel
.p2align 8
.type standalone__gqa_block_cached__near_ridge_kernel,@function
standalone__gqa_block_cached__near_ridge_kernel:
    s_cmp_ge_u32 s2, 256
    s_cbranch_scc1 L_exit
    s_load_dwordx16 s[4:19], s[0:1], 0
    v_lshrrev_b32 v2, 6, v0
    v_and_b32 v1, 63, v0
    v_readfirstlane_b32 s52, v2
    s_and_b32 s53, s2, 7
    s_bfe_u32 s54, s2, 0x20003
    s_lshr_b32 s55, s2, 5
    s_cmp_lt_u32 s52, 4
    s_cbranch_scc1 L_mfma
    s_sub_u32 s59, s52, 4
    s_lshl2_add_u32 s63, s53, s54
    s_lshl_b32 s56, s63, 8
    s_lshl_b32 s57, s59, 16
    s_add_u32 s56, s56, s57
    s_lshl2_add_u32 s57, s55, s59
    s_mul_i32 s57, s57, 18432
    s_lshl_b32 s61, s59, 11
    s_add_u32 s58, s55, s54
    s_lshl_b32 s58, s58, 1
    s_lshr_b32 s62, 0x924924, s58
    s_bfe_u32 s58, s62, 0x20000
    s_mul_i32 s64, s58, 1572864
    s_add_u32 s64, s64, s56
    s_mul_i32 s67, s58, 384
    s_add_u32 s67, s67, s57
    v_lshrrev_b32 v2, 3, v1
    v_mul_u32_u24 v2, 1152, v2
    v_lshrrev_b32 v3, 4, v1
    v_and_b32 v4, 7, v1
    v_xor_b32 v3, v3, v4
    v_lshl_add_u32 v10, v3, 4, v2
    v_xor_b32 v3, 4, v3
    v_lshl_add_u32 v4, v3, 4, v2
    v_add_u32 v11, 8192, v4
    v_lshrrev_b32 v2, 4, v1
    v_lshlrev_b32 v3, 2, v2
    v_and_b32 v4, 15, v1
    v_xor_b32 v3, v3, v4
    v_lshlrev_b32 v3, 4, v3
    v_lshl_add_u32 v8, v2, 13, v3
    v_add_u32 v9, 31744, v8
    s_mov_b32 s26, 589824
    s_mov_b32 s27, 0x00020000
    s_mov_b32 s22, 4718592
    s_mov_b32 s23, 0x00020000
    s_waitcnt lgkmcnt(0)
    s_mov_b64 s[24:25], s[4:5]
    s_mov_b64 s[20:21], s[10:11]
    s_add_u32 m0, s61, 0
    s_add_u32 s60, s67, 0
    buffer_load_dwordx4 v10, s[24:27], s60 offen offset:0 lds
    buffer_load_dwordx4 v11, s[24:27], s60 offen offset:1024 lds
    s_add_u32 m0, s61, 8192
    s_add_u32 s60, s64, 0
    buffer_load_dwordx4 v8, s[20:23], s60 offen offset:0 lds
    buffer_load_dwordx4 v9, s[20:23], s60 offen offset:1024 lds
    s_add_u32 m0, s61, 16384
    s_add_u32 s60, s64, 262144
    buffer_load_dwordx4 v8, s[20:23], s60 offen offset:0 lds
    buffer_load_dwordx4 v9, s[20:23], s60 offen offset:1024 lds
    s_add_u32 m0, s61, 24576
    s_add_u32 s60, s67, 128
    buffer_load_dwordx4 v10, s[24:27], s60 offen offset:0 lds
    buffer_load_dwordx4 v11, s[24:27], s60 offen offset:1024 lds
    s_add_u32 m0, s61, 32768
    s_add_u32 s60, s64, 524288
    buffer_load_dwordx4 v8, s[20:23], s60 offen offset:0 lds
    buffer_load_dwordx4 v9, s[20:23], s60 offen offset:1024 lds
    s_add_u32 m0, s61, 40960
    s_add_u32 s60, s64, 786432
    buffer_load_dwordx4 v8, s[20:23], s60 offen offset:0 lds
    buffer_load_dwordx4 v9, s[20:23], s60 offen offset:1024 lds
    s_add_u32 m0, s61, 49152
    s_add_u32 s60, s67, 256
    buffer_load_dwordx4 v10, s[24:27], s60 offen offset:0 lds
    buffer_load_dwordx4 v11, s[24:27], s60 offen offset:1024 lds
    s_add_u32 s100, s18, 0x1ff000
    s_addc_u32 s101, s19, 0
    s_load_dword s79, s[100:101], 0
    s_bfe_u32 s58, s62, 0x20002
    s_mul_i32 s65, s58, 1572864
    s_add_u32 s65, s65, s56
    s_mul_i32 s68, s58, 384
    s_add_u32 s68, s68, s57
    s_bfe_u32 s58, s62, 0x20004
    s_mul_i32 s66, s58, 1572864
    s_add_u32 s66, s66, s56
    s_mul_i32 s69, s58, 384
    s_add_u32 s69, s69, s57
    s_mov_b32 s28, s6
    s_mov_b32 s29, s7
    s_mov_b32 s30, 0x200000
    s_mov_b32 s31, 0x00020000
    s_mov_b32 s32, s8
    s_mov_b32 s33, s9
    s_mov_b32 s35, 0x00020000
    s_mov_b32 s36, s12
    s_mov_b32 s37, s13
    s_mov_b32 s39, 0x00020000
    s_cmp_lt_u32 s2, 192
    s_cselect_b32 s34, 2097152, 0
    s_cselect_b32 s38, 4718592, 0
    s_mov_b32 s40, s18
    s_mov_b32 s41, s19
    s_mov_b32 s42, 0x1000000
    s_mov_b32 s43, 0x00020000
    s_mov_b32 s48, s14
    s_mov_b32 s49, s15
    s_mov_b32 s50, 0x90000
    s_mov_b32 s51, 0x00020000
    s_lshr_b32 s56, s59, 1
    s_and_b32 s57, s59, 1
    s_lshl_b32 s58, s56, 7
    s_lshl_b32 s70, s57, 12
    s_add_u32 s58, s58, s70
    s_lshr_b32 s70, s63, 1
    s_lshl_b32 s70, s70, 13
    s_lshl_b32 s62, s55, 18
    s_add_u32 s70, s70, s62
    s_add_u32 s70, s70, s58
    s_lshl1_add_u32 s77, s55, s56
    s_lshl_b32 s77, s77, 5
    s_add_u32 s77, s77, s63
    s_lshl_b32 s77, s77, 11
    v_and_b32 v2, 47, v1
    v_lshlrev_b32 v2, 4, v2
    s_lshl_b32 s57, s57, 8
    v_add_u32 v2, s57, v2
    v_bfe_u32 v3, v1, 4, 1
    v_lshl_add_u32 v19, v3, 10, v2
    v_lshl_add_u32 v18, v3, 11, v2
    s_lshl_b32 s56, s56, 13
    s_add_u32 s56, s56, 147456
    v_add_u32 v18, s56, v18
    s_add_u32 s56, s54, s55
    s_and_b32 s56, s56, 1
    s_lshl1_add_u32 s56, s53, s56
    s_xor_b32 s57, s56, 1
    s_lshl_b32 s62, s54, 19
    s_add_u32 s58, s58, s62
    s_lshl_b32 s71, s56, 13
    s_add_u32 s71, s71, s58
    s_mul_i32 s73, s56, 294912
    s_lshl_b32 s72, s57, 13
    s_add_u32 s72, s72, s58
    s_mul_i32 s74, s57, 294912
    s_mul_i32 s56, s55, 192
    s_and_b32 s57, s55, 1
    s_lshl_b32 s58, s57, 7
    s_sub_u32 s58, s56, s58
    s_mul_i32 s62, s59, 36864
    s_add_u32 s58, s58, s62
    s_add_u32 s58, s58, 128
    s_lshl_b32 s57, s57, 6
    s_add_u32 s56, s56, s57
    s_mul_i32 s62, s59, 18432
    s_add_u32 s56, s56, s62
    s_add_u32 s75, s73, s58
    s_add_u32 s73, s73, s56
    s_add_u32 s76, s74, s58
    s_add_u32 s74, s74, s56
    v_lshrrev_b32 v2, 3, v1
    v_mul_u32_u24 v2, 256, v2
    v_lshrrev_b32 v3, 4, v1
    v_and_b32 v4, 7, v1
    v_xor_b32 v3, v3, v4
    v_lshl_add_u32 v12, v3, 4, v2
    v_xor_b32 v3, 4, v3
    v_lshl_add_u32 v4, v3, 4, v2
    v_add_u32 v13, 1024, v4
    v_lshrrev_b32 v2, 3, v1
    v_mul_u32_u24 v2, 1152, v2
    v_bfe_u32 v3, v1, 4, 1
    v_lshlrev_b32 v3, 2, v3
    v_and_b32 v4, 7, v1
    v_xor_b32 v3, v3, v4
    v_lshl_add_u32 v14, v3, 4, v2
    v_add_u32 v15, 8192, v14
    v_lshrrev_b32 v2, 2, v1
    v_mul_u32_u24 v2, 1152, v2
    v_and_b32 v3, 3, v1
    v_lshl_add_u32 v16, v3, 4, v2
    v_add_u32 v17, 17408, v16
    s_mov_b32 s100, 0x3e0293ee
    s_mov_b32 s101, 0x7fff7fff
    s_waitcnt vmcnt(13)
    s_add_u32 m0, s61, 57344
    s_add_u32 s60, s64, 1048576
    buffer_load_dwordx4 v8, s[20:23], s60 offen offset:0 lds
    s_waitcnt vmcnt(13)
    buffer_load_dwordx4 v9, s[20:23], s60 offen offset:1024 lds
    s_waitcnt vmcnt(13)
    s_add_u32 m0, s61, 65536
    s_add_u32 s60, s64, 1310720
    buffer_load_dwordx4 v8, s[20:23], s60 offen offset:0 lds
    s_waitcnt vmcnt(13)
    buffer_load_dwordx4 v9, s[20:23], s60 offen offset:1024 lds
    s_waitcnt vmcnt(13)
    s_add_u32 m0, s61, 73728
    s_add_u32 s60, s68, 0
    buffer_load_dwordx4 v10, s[24:27], s60 offen offset:0 lds
    s_waitcnt vmcnt(13)
    s_barrier
    buffer_load_dwordx4 v11, s[24:27], s60 offen offset:1024 lds
    s_waitcnt vmcnt(13)
    s_add_u32 m0, s61, 81920
    s_add_u32 s60, s65, 0
    buffer_load_dwordx4 v8, s[20:23], s60 offen offset:0 lds
    s_waitcnt vmcnt(13)
    buffer_load_dwordx4 v9, s[20:23], s60 offen offset:1024 lds
    s_waitcnt vmcnt(13)
    s_add_u32 m0, s61, 90112
    s_add_u32 s60, s65, 262144
    buffer_load_dwordx4 v8, s[20:23], s60 offen offset:0 lds
    s_waitcnt vmcnt(13)
    buffer_load_dwordx4 v9, s[20:23], s60 offen offset:1024 lds
    s_waitcnt vmcnt(13)
    s_add_u32 m0, s61, 147456
    s_add_u32 s60, s70, 0
    buffer_load_dwordx4 v12, s[28:31], s60 offen offset:0 lds
    s_waitcnt vmcnt(13)
    s_barrier
    buffer_load_dwordx4 v13, s[28:31], s60 offen offset:1024 lds
    s_waitcnt vmcnt(13)
    s_add_u32 m0, s61, 155648
    s_add_u32 s60, s70, 131072
    buffer_load_dwordx4 v12, s[28:31], s60 offen offset:0 lds
    s_waitcnt vmcnt(13)
    buffer_load_dwordx4 v13, s[28:31], s60 offen offset:1024 lds
    s_waitcnt vmcnt(13)
    s_add_u32 m0, s61, 98304
    s_add_u32 s60, s68, 128
    buffer_load_dwordx4 v10, s[24:27], s60 offen offset:0 lds
    s_waitcnt vmcnt(13)
    buffer_load_dwordx4 v11, s[24:27], s60 offen offset:1024 lds
    s_waitcnt vmcnt(13)
    s_add_u32 m0, s61, 106496
    s_add_u32 s60, s65, 524288
    buffer_load_dwordx4 v8, s[20:23], s60 offen offset:0 lds
    s_waitcnt vmcnt(13)
    s_barrier
    buffer_load_dwordx4 v9, s[20:23], s60 offen offset:1024 lds
    s_waitcnt vmcnt(13)
    s_add_u32 m0, s61, 0
    s_add_u32 s60, s65, 786432
    buffer_load_dwordx4 v8, s[20:23], s60 offen offset:0 lds
    s_waitcnt vmcnt(13)
    buffer_load_dwordx4 v9, s[20:23], s60 offen offset:1024 lds
    s_waitcnt vmcnt(13)
    s_add_u32 m0, s61, 8192
    s_add_u32 s60, s68, 256
    buffer_load_dwordx4 v10, s[24:27], s60 offen offset:0 lds
    s_waitcnt vmcnt(13)
    buffer_load_dwordx4 v11, s[24:27], s60 offen offset:1024 lds
    s_waitcnt vmcnt(13)
    s_add_u32 m0, s61, 16384
    s_add_u32 s60, s65, 1048576
    buffer_load_dwordx4 v8, s[20:23], s60 offen offset:0 lds
    s_waitcnt vmcnt(13)
    s_barrier
    buffer_load_dwordx4 v9, s[20:23], s60 offen offset:1024 lds
    s_waitcnt vmcnt(13)
    s_add_u32 m0, s61, 24576
    s_add_u32 s60, s65, 1310720
    buffer_load_dwordx4 v8, s[20:23], s60 offen offset:0 lds
    s_waitcnt vmcnt(13)
    buffer_load_dwordx4 v9, s[20:23], s60 offen offset:1024 lds
    s_waitcnt vmcnt(13)
    s_add_u32 m0, s61, 32768
    s_add_u32 s60, s69, 0
    buffer_load_dwordx4 v10, s[24:27], s60 offen offset:0 lds
    s_waitcnt vmcnt(13)
    buffer_load_dwordx4 v11, s[24:27], s60 offen offset:1024 lds
    s_waitcnt vmcnt(13)
    s_add_u32 m0, s61, 40960
    s_add_u32 s60, s66, 0
    buffer_load_dwordx4 v8, s[20:23], s60 offen offset:0 lds
    s_waitcnt vmcnt(13)
    buffer_load_dwordx4 v9, s[20:23], s60 offen offset:1024 lds
    s_waitcnt vmcnt(10)
    s_barrier
    s_add_u32 m0, s61, 49152
    s_add_u32 s60, s66, 262144
    buffer_load_dwordx4 v8, s[20:23], s60 offen offset:0 lds
    buffer_load_dwordx4 v9, s[20:23], s60 offen offset:1024 lds
    s_add_u32 m0, s61, 57344
    s_add_u32 s60, s69, 128
    buffer_load_dwordx4 v10, s[24:27], s60 offen offset:0 lds
    buffer_load_dwordx4 v11, s[24:27], s60 offen offset:1024 lds
    s_waitcnt vmcnt(13)
    s_add_u32 m0, s61, 65536
    s_add_u32 s60, s66, 524288
    buffer_load_dwordx4 v8, s[20:23], s60 offen offset:0 lds
    s_waitcnt vmcnt(13)
    buffer_load_dwordx4 v9, s[20:23], s60 offen offset:1024 lds
    s_waitcnt lgkmcnt(0)
    s_add_u32 s79, s79, 0x11111111
    v_mov_b32 v20, s79
    v_and_b32 v92, 0xffff7777, v20
    v_or_b32 v92, 0x4444, v92
    v_and_b32 v21, 3, v1
    v_lshlrev_b32 v21, 2, v21
    v_lshrrev_b32 v92, v21, v92
    v_lshlrev_b32 v95, 12, v92
    v_and_b32 v95, 0x80008000, v95
    v_lshlrev_b32 v94, 13, v92
    v_and_b32 v94, 0x80008000, v94
    v_lshlrev_b32 v93, 14, v92
    v_and_b32 v93, 0x80008000, v93
    v_lshlrev_b32 v92, 15, v92
    v_and_b32 v92, 0x80008000, v92
    s_waitcnt vmcnt(10)
    s_barrier
    s_add_u32 m0, s61, 73728
    s_add_u32 s60, s66, 786432
    buffer_load_dwordx4 v8, s[20:23], s60 offen offset:0 lds
    buffer_load_dwordx4 v9, s[20:23], s60 offen offset:1024 lds
    s_add_u32 m0, s61, 81920
    s_add_u32 s60, s69, 256
    buffer_load_dwordx4 v10, s[24:27], s60 offen offset:0 lds
    buffer_load_dwordx4 v11, s[24:27], s60 offen offset:1024 lds
    s_waitcnt vmcnt(13)
    s_add_u32 m0, s61, 90112
    s_add_u32 s60, s66, 1048576
    buffer_load_dwordx4 v8, s[20:23], s60 offen offset:0 lds
    s_waitcnt vmcnt(13)
    buffer_load_dwordx4 v9, s[20:23], s60 offen offset:1024 lds
    s_waitcnt vmcnt(10)
    s_barrier
    s_add_u32 m0, s61, 98304
    s_add_u32 s60, s66, 1310720
    buffer_load_dwordx4 v8, s[20:23], s60 offen offset:0 lds
    buffer_load_dwordx4 v9, s[20:23], s60 offen offset:1024 lds
    s_add_u32 m0, s61, 114688
    s_add_u32 s60, s71, 0
    buffer_load_dwordx4 v12, s[32:35], s60 offen offset:0 lds
    buffer_load_dwordx4 v13, s[32:35], s60 offen offset:1024 lds
    s_waitcnt vmcnt(13)
    s_add_u32 m0, s61, 122880
    s_add_u32 s60, s71, 131072
    buffer_load_dwordx4 v12, s[32:35], s60 offen offset:0 lds
    s_waitcnt vmcnt(13)
    buffer_load_dwordx4 v13, s[32:35], s60 offen offset:1024 lds
    s_waitcnt vmcnt(13)
    s_add_u32 m0, s61, 131072
    s_add_u32 s60, s71, 262144
    buffer_load_dwordx4 v12, s[32:35], s60 offen offset:0 lds
    s_waitcnt vmcnt(13)
    buffer_load_dwordx4 v13, s[32:35], s60 offen offset:1024 lds
    s_waitcnt vmcnt(13)
    s_add_u32 m0, s61, 139264
    s_add_u32 s60, s71, 393216
    buffer_load_dwordx4 v12, s[32:35], s60 offen offset:0 lds
    s_waitcnt vmcnt(13)
    s_barrier
    buffer_load_dwordx4 v13, s[32:35], s60 offen offset:1024 lds
    s_waitcnt vmcnt(13)
    s_add_u32 m0, s61, 106496
    s_add_u32 s60, s73, 0
    buffer_load_dwordx4 v14, s[36:39], s60 offen offset:0 lds
    s_waitcnt vmcnt(13)
    buffer_load_dwordx4 v15, s[36:39], s60 offen offset:1024 lds
    s_waitcnt vmcnt(13)
    s_add_u32 m0, s61, 0
    s_add_u32 s60, s73, 73728
    buffer_load_dwordx4 v14, s[36:39], s60 offen offset:0 lds
    s_waitcnt vmcnt(13)
    s_barrier
    buffer_load_dwordx4 v15, s[36:39], s60 offen offset:1024 lds
    s_waitcnt vmcnt(13)
    s_add_u32 m0, s61, 8192
    s_add_u32 s60, s75, 0
    buffer_load_dwordx4 v16, s[36:39], s60 offen offset:0 lds
    s_waitcnt vmcnt(13)
    s_barrier
    buffer_load_dwordx4 v17, s[36:39], s60 offen offset:1024 lds
    s_waitcnt vmcnt(13)
    s_add_u32 m0, s61, 16384
    s_add_u32 s60, s73, 147456
    buffer_load_dwordx4 v14, s[36:39], s60 offen offset:0 lds
    s_waitcnt vmcnt(13)
    buffer_load_dwordx4 v15, s[36:39], s60 offen offset:1024 lds
    s_waitcnt vmcnt(13)
    s_add_u32 m0, s61, 24576
    s_add_u32 s60, s73, 221184
    buffer_load_dwordx4 v14, s[36:39], s60 offen offset:0 lds
    s_waitcnt vmcnt(13)
    buffer_load_dwordx4 v15, s[36:39], s60 offen offset:1024 lds
    s_waitcnt vmcnt(13)
    s_add_u32 m0, s61, 32768
    s_add_u32 s60, s75, 147456
    buffer_load_dwordx4 v16, s[36:39], s60 offen offset:0 lds
    s_waitcnt vmcnt(13)
    buffer_load_dwordx4 v17, s[36:39], s60 offen offset:1024 lds
    s_waitcnt vmcnt(13)
    s_add_u32 m0, s61, 40960
    s_add_u32 s60, s72, 0
    buffer_load_dwordx4 v12, s[32:35], s60 offen offset:0 lds
    s_waitcnt vmcnt(13)
    buffer_load_dwordx4 v13, s[32:35], s60 offen offset:1024 lds
    s_waitcnt vmcnt(13)
    s_add_u32 m0, s61, 49152
    s_add_u32 s60, s72, 131072
    buffer_load_dwordx4 v12, s[32:35], s60 offen offset:0 lds
    s_waitcnt vmcnt(13)
    s_barrier
    ds_read_b128 v[24:27], v18 offset:0
    ds_read_b128 v[28:31], v18 offset:1024
    ds_read_b128 v[32:35], v18 offset:4096
    ds_read_b128 v[36:39], v18 offset:5120
    s_waitcnt lgkmcnt(0)
    v_add_f32 v24, v24, v32
    v_add_f32 v25, v25, v33
    v_add_f32 v26, v26, v34
    v_add_f32 v27, v27, v35
    v_add_f32 v28, v28, v36
    v_add_f32 v29, v29, v37
    v_add_f32 v30, v30, v38
    v_add_f32 v31, v31, v39
    v_max3_f32 v40, v24, v25, v26
    v_max3_f32 v41, v27, v28, v29
    v_max3_f32 v40, v40, v30, v31
    v_max_f32 v40, v40, v41
    v_mov_b32 v41, v40
    s_nop 1
    v_permlane16_swap_b32 v40, v41
    s_nop 0
    v_max_f32 v40, v40, v41
    v_mov_b32 v41, v40
    s_nop 1
    v_permlane32_swap_b32 v40, v41
    s_nop 0
    v_max_f32 v40, v40, v41
    s_cmp_ge_u32 s2, 192
    s_cbranch_scc1 L_nomid_1
    s_waitcnt vmcnt(11)
    s_barrier
L_nomid_1:
    v_mul_f32 v40, s100, v40
    v_fma_f32 v24, v24, s100, -v40
    v_fma_f32 v25, v25, s100, -v40
    v_fma_f32 v26, v26, s100, -v40
    v_fma_f32 v27, v27, s100, -v40
    v_fma_f32 v28, v28, s100, -v40
    v_fma_f32 v29, v29, s100, -v40
    v_fma_f32 v30, v30, s100, -v40
    v_fma_f32 v31, v31, s100, -v40
    v_exp_f32 v24, v24
    v_exp_f32 v25, v25
    v_exp_f32 v26, v26
    v_exp_f32 v27, v27
    v_exp_f32 v28, v28
    v_exp_f32 v29, v29
    v_exp_f32 v30, v30
    v_exp_f32 v31, v31
    s_nop 0
    v_add_f32 v40, v24, v25
    v_add_f32 v41, v26, v27
    v_add_f32 v42, v28, v29
    v_add_f32 v43, v30, v31
    v_add_f32 v40, v40, v42
    v_add_f32 v41, v41, v43
    s_cmp_ge_u32 s2, 192
    s_cbranch_scc1 L_nomid_2
    s_waitcnt vmcnt(9)
    s_barrier
L_nomid_2:
    v_add_f32 v40, v40, v41
    v_mov_b32 v41, v40
    s_nop 1
    v_permlane16_swap_b32 v40, v41
    s_nop 0
    v_add_f32 v40, v40, v41
    v_mov_b32 v41, v40
    s_nop 1
    v_permlane32_swap_b32 v40, v41
    s_nop 0
    v_add_f32 v40, v40, v41
    v_rcp_f32 v40, v40
    s_nop 0
    v_mul_f32 v24, v24, v40
    v_mul_f32 v25, v25, v40
    v_mul_f32 v26, v26, v40
    v_mul_f32 v27, v27, v40
    v_mul_f32 v28, v28, v40
    v_mul_f32 v29, v29, v40
    v_mul_f32 v30, v30, v40
    v_mul_f32 v31, v31, v40
    v_cvt_pk_bf16_f32 v44, v24, v25
    v_cvt_pk_bf16_f32 v45, v26, v27
    v_cvt_pk_bf16_f32 v46, v28, v29
    v_cvt_pk_bf16_f32 v47, v30, v31
    v_and_or_b32 v44, v44, s101, v92
    v_and_or_b32 v45, v45, s101, v93
    v_and_or_b32 v46, v46, s101, v94
    v_and_or_b32 v47, v47, s101, v95
    buffer_store_dwordx4 v[44:47], v19, s[40:43], s77 offen sc1
    s_cmp_ge_u32 s2, 192
    s_cbranch_scc1 L_done
    buffer_load_dwordx4 v13, s[32:35], s60 offen offset:1024 lds
    s_add_u32 m0, s61, 57344
    s_add_u32 s60, s72, 262144
    buffer_load_dwordx4 v12, s[32:35], s60 offen offset:0 lds
    buffer_load_dwordx4 v13, s[32:35], s60 offen offset:1024 lds
    s_add_u32 m0, s61, 65536
    s_add_u32 s60, s72, 393216
    buffer_load_dwordx4 v12, s[32:35], s60 offen offset:0 lds
    buffer_load_dwordx4 v13, s[32:35], s60 offen offset:1024 lds
    s_waitcnt vmcnt(14)
    s_add_u32 m0, s61, 73728
    s_add_u32 s60, s74, 0
    buffer_load_dwordx4 v14, s[36:39], s60 offen offset:0 lds
    s_waitcnt vmcnt(14)
    s_barrier
    buffer_load_dwordx4 v15, s[36:39], s60 offen offset:1024 lds
    s_waitcnt vmcnt(14)
    s_add_u32 m0, s61, 81920
    s_add_u32 s60, s74, 73728
    buffer_load_dwordx4 v14, s[36:39], s60 offen offset:0 lds
    s_waitcnt vmcnt(14)
    s_barrier
    buffer_load_dwordx4 v15, s[36:39], s60 offen offset:1024 lds
    s_waitcnt vmcnt(14)
    s_add_u32 m0, s61, 90112
    s_add_u32 s60, s76, 0
    buffer_load_dwordx4 v16, s[36:39], s60 offen offset:0 lds
    s_waitcnt vmcnt(14)
    s_barrier
    buffer_load_dwordx4 v17, s[36:39], s60 offen offset:1024 lds
    s_waitcnt vmcnt(14)
    s_add_u32 m0, s61, 98304
    s_add_u32 s60, s74, 147456
    buffer_load_dwordx4 v14, s[36:39], s60 offen offset:0 lds
    s_waitcnt vmcnt(14)
    buffer_load_dwordx4 v15, s[36:39], s60 offen offset:1024 lds
    s_waitcnt vmcnt(14)
    s_add_u32 m0, s61, 106496
    s_add_u32 s60, s74, 221184
    buffer_load_dwordx4 v14, s[36:39], s60 offen offset:0 lds
    s_waitcnt vmcnt(13)
    buffer_load_dwordx4 v15, s[36:39], s60 offen offset:1024 lds
    s_waitcnt vmcnt(13)
    s_add_u32 m0, s61, 0
    s_add_u32 s60, s76, 147456
    buffer_load_dwordx4 v16, s[36:39], s60 offen offset:0 lds
    s_waitcnt vmcnt(13)
    buffer_load_dwordx4 v17, s[36:39], s60 offen offset:1024 lds
    s_waitcnt vmcnt(10)
    s_barrier
    s_waitcnt vmcnt(6)
    s_barrier
    s_waitcnt vmcnt(4)
    s_barrier
    s_waitcnt vmcnt(0)
    s_barrier
    s_lshr_b32 s56, s53, 1
    s_lshl2_add_u32 s56, s54, s56
    s_and_b32 s57, s53, 1
    s_mul_i32 s58, s55, 3
    s_and_b32 s62, s55, 1
    s_add_u32 s67, s58, s62
    s_lshl_b32 s62, s62, 1
    s_sub_u32 s69, s58, s62
    s_add_u32 s69, s69, 2
    s_mul_i32 s58, s56, 294912
    s_lshl1_add_u32 s62, s59, s57
    s_lshl_b32 s62, s62, 8
    s_add_u32 s58, s58, s62
    s_add_u32 s58, s58, 0x800000
    s_lshl1_add_u32 s56, s56, s57
    s_mul_i32 s56, s56, 18432
    s_lshl4_add_u32 s56, s59, s56
    s_lshl_b32 s64, s67, 14
    s_add_u32 s64, s64, s58
    s_lshl_b32 s67, s67, 6
    s_add_u32 s67, s67, s56
    s_lshl_b32 s66, s69, 14
    s_add_u32 s66, s66, s58
    s_lshl_b32 s69, s69, 6
    s_add_u32 s69, s69, s56
    s_add_u32 s65, s64, 16384
    s_add_u32 s68, s67, 64
    v_and_b32 v2, 15, v1
    v_lshrrev_b32 v3, 4, v1
    v_lshlrev_b32 v8, 4, v2
    v_lshl_add_u32 v8, v3, 11, v8
    v_add_u32 v9, 8192, v8
    v_mul_u32_u24 v23, 1152, v2
    v_lshl_add_u32 v23, v3, 3, v23
    v_and_b32 v3, 1, v1
    v_lshlrev_b32 v3, 4, v3
    v_mov_b32 v4, 0x3f00
    v_lshlrev_b32 v3, v3, v4
    v_lshrrev_b32 v2, 1, v2
    v_cmp_eq_u32 vcc, 0, v2
    v_cndmask_b32 v12, 0, v3, vcc
    v_cmp_eq_u32 vcc, 1, v2
    v_cndmask_b32 v13, 0, v3, vcc
    v_cmp_eq_u32 vcc, 2, v2
    v_cndmask_b32 v14, 0, v3, vcc
    v_cmp_eq_u32 vcc, 3, v2
    v_cndmask_b32 v15, 0, v3, vcc
    v_lshrrev_b32 v92, 15, v92
    v_lshrrev_b32 v93, 15, v93
    v_lshrrev_b32 v94, 15, v94
    v_lshrrev_b32 v95, 15, v95
    s_mov_b32 s101, 0x00010001
    s_mov_b32 s62, 8192
    s_barrier
    buffer_load_dwordx4 v[48:51], v8, s[40:43], s64 offen sc1
    buffer_load_dwordx4 v[52:55], v9, s[40:43], s64 offen sc1
    s_barrier
    buffer_load_dwordx4 v[56:59], v8, s[40:43], s65 offen sc1
    buffer_load_dwordx4 v[60:63], v9, s[40:43], s65 offen sc1
    s_barrier
    buffer_load_dwordx4 v[64:67], v8, s[40:43], s66 offen sc1
    buffer_load_dwordx4 v[68:71], v9, s[40:43], s66 offen sc1
    s_waitcnt vmcnt(4)
L_fin0:
    v_xor_b32 v48, v92, v48
    v_xor_b32 v49, v93, v49
    v_xor_b32 v50, v94, v50
    v_xor_b32 v51, v95, v51
    v_xor_b32 v52, v92, v52
    v_xor_b32 v53, v93, v53
    v_xor_b32 v54, v94, v54
    v_xor_b32 v55, v95, v55
    v_mfma_f32_16x16x32_bf16 v[80:83], v[12:15], v[48:51], 0
    v_or_b32 v24, s101, v48
    v_or_b32 v25, s101, v49
    v_or_b32 v26, s101, v50
    v_or_b32 v27, s101, v51
    v_mfma_f32_16x16x32_bf16 v[80:83], v[12:15], v[52:55], v[80:83]
    v_or_b32 v28, s101, v52
    v_or_b32 v29, s101, v53
    v_or_b32 v30, s101, v54
    v_or_b32 v31, s101, v55
    v_mfma_f32_16x16x32_bf16 v[80:83], v[12:15], v[24:27], v[80:83]
    v_or3_b32 v2, v48, v49, v50
    v_or3_b32 v3, v51, v52, v53
    v_mfma_f32_16x16x32_bf16 v[80:83], v[12:15], v[28:31], v[80:83]
    v_or3_b32 v2, v2, v54, v55
    v_or_b32 v2, v2, v3
    v_and_b32 v2, s101, v2
    v_cmp_ne_u32 vcc, 0, v2
    s_cbranch_vccnz L_fslow0
L_fok0:
    s_nop 4
    v_cvt_pk_bf16_f32 v84, v80, v81
    v_cvt_pk_bf16_f32 v85, v82, v83
    s_mov_b32 exec_hi, 0
    buffer_store_dwordx2 v[84:85], v23, s[48:51], s67 offen
    s_mov_b64 exec, -1
    s_waitcnt vmcnt(3)
L_fin1:
    v_xor_b32 v56, v92, v56
    v_xor_b32 v57, v93, v57
    v_xor_b32 v58, v94, v58
    v_xor_b32 v59, v95, v59
    v_xor_b32 v60, v92, v60
    v_xor_b32 v61, v93, v61
    v_xor_b32 v62, v94, v62
    v_xor_b32 v63, v95, v63
    v_mfma_f32_16x16x32_bf16 v[80:83], v[12:15], v[56:59], 0
    v_or_b32 v24, s101, v56
    v_or_b32 v25, s101, v57
    v_or_b32 v26, s101, v58
    v_or_b32 v27, s101, v59
    v_mfma_f32_16x16x32_bf16 v[80:83], v[12:15], v[60:63], v[80:83]
    v_or_b32 v28, s101, v60
    v_or_b32 v29, s101, v61
    v_or_b32 v30, s101, v62
    v_or_b32 v31, s101, v63
    v_mfma_f32_16x16x32_bf16 v[80:83], v[12:15], v[24:27], v[80:83]
    v_or3_b32 v2, v56, v57, v58
    v_or3_b32 v3, v59, v60, v61
    v_mfma_f32_16x16x32_bf16 v[80:83], v[12:15], v[28:31], v[80:83]
    v_or3_b32 v2, v2, v62, v63
    v_or_b32 v2, v2, v3
    v_and_b32 v2, s101, v2
    v_cmp_ne_u32 vcc, 0, v2
    s_cbranch_vccnz L_fslow1
L_fok1:
    s_nop 4
    v_cvt_pk_bf16_f32 v86, v80, v81
    v_cvt_pk_bf16_f32 v87, v82, v83
    s_mov_b32 exec_hi, 0
    buffer_store_dwordx2 v[86:87], v23, s[48:51], s68 offen
    s_mov_b64 exec, -1
    s_waitcnt vmcnt(2)
L_fin2:
    v_xor_b32 v64, v92, v64
    v_xor_b32 v65, v93, v65
    v_xor_b32 v66, v94, v66
    v_xor_b32 v67, v95, v67
    v_xor_b32 v68, v92, v68
    v_xor_b32 v69, v93, v69
    v_xor_b32 v70, v94, v70
    v_xor_b32 v71, v95, v71
    v_mfma_f32_16x16x32_bf16 v[80:83], v[12:15], v[64:67], 0
    v_or_b32 v24, s101, v64
    v_or_b32 v25, s101, v65
    v_or_b32 v26, s101, v66
    v_or_b32 v27, s101, v67
    v_mfma_f32_16x16x32_bf16 v[80:83], v[12:15], v[68:71], v[80:83]
    v_or_b32 v28, s101, v68
    v_or_b32 v29, s101, v69
    v_or_b32 v30, s101, v70
    v_or_b32 v31, s101, v71
    v_mfma_f32_16x16x32_bf16 v[80:83], v[12:15], v[24:27], v[80:83]
    v_or3_b32 v2, v64, v65, v66
    v_or3_b32 v3, v67, v68, v69
    v_mfma_f32_16x16x32_bf16 v[80:83], v[12:15], v[28:31], v[80:83]
    v_or3_b32 v2, v2, v70, v71
    v_or_b32 v2, v2, v3
    v_and_b32 v2, s101, v2
    v_cmp_ne_u32 vcc, 0, v2
    s_cbranch_vccnz L_fslow2
L_fok2:
    s_nop 4
    v_cvt_pk_bf16_f32 v88, v80, v81
    v_cvt_pk_bf16_f32 v89, v82, v83
    s_mov_b32 exec_hi, 0
    buffer_store_dwordx2 v[88:89], v23, s[48:51], s69 offen
    s_mov_b64 exec, -1
    s_endpgm
L_fslow0:
    s_sub_u32 s62, s62, 1
    s_cbranch_scc1 L_fok0
    buffer_load_dwordx4 v[48:51], v8, s[40:43], s64 offen sc1
    buffer_load_dwordx4 v[52:55], v9, s[40:43], s64 offen sc1
    buffer_load_dwordx4 v[56:59], v8, s[40:43], s65 offen sc1
    buffer_load_dwordx4 v[60:63], v9, s[40:43], s65 offen sc1
    buffer_load_dwordx4 v[64:67], v8, s[40:43], s66 offen sc1
    buffer_load_dwordx4 v[68:71], v9, s[40:43], s66 offen sc1
    s_waitcnt vmcnt(0)
    s_branch L_fin0
L_fslow1:
    s_sub_u32 s62, s62, 1
    s_cbranch_scc1 L_fok1
    buffer_load_dwordx4 v[56:59], v8, s[40:43], s65 offen sc1
    buffer_load_dwordx4 v[60:63], v9, s[40:43], s65 offen sc1
    buffer_load_dwordx4 v[64:67], v8, s[40:43], s66 offen sc1
    buffer_load_dwordx4 v[68:71], v9, s[40:43], s66 offen sc1
    s_waitcnt vmcnt(0)
    s_branch L_fin1
L_fslow2:
    s_sub_u32 s62, s62, 1
    s_cbranch_scc1 L_fok2
    buffer_load_dwordx4 v[64:67], v8, s[40:43], s66 offen sc1
    buffer_load_dwordx4 v[68:71], v9, s[40:43], s66 offen sc1
    s_waitcnt vmcnt(0)
    s_branch L_fin2
L_mfma:
    v_lshlrev_b32 v15, 4, v1
    s_getpc_b64 s[76:77]
L_pc:
    s_sub_u32 s76, s76, L_pc-standalone__gqa_block_cached__near_ridge_kernel
    s_subb_u32 s77, s77, 0
    s_mov_b32 s78, L_end-standalone__gqa_block_cached__near_ridge_kernel
    s_mov_b32 s79, 0x00020000
    s_lshl_b32 s56, s52, 13
    v_lshlrev_b32 v2, 7, v1
    buffer_load_dword v6, v2, s[76:79], s56 offen
    s_lshr_b32 s56, s52, 1
    s_and_b32 s58, s52, 1
    s_lshl2_add_u32 s59, s54, s52
    s_mul_i32 s66, s59, 18
    s_mul_i32 s60, s55, 3
    s_add_u32 s66, s66, s60
    s_and_b32 s60, s55, 1
    s_lshl_b32 s61, s60, 1
    s_sub_u32 s68, s66, s61
    s_add_u32 s68, s68, 2
    s_add_u32 s66, s66, s60
    s_add_u32 s67, s66, 1
    s_mov_b32 s61, s53
    s_and_b32 s61, s61, 7
    s_lshl3_add_u32 s66, s66, s61
    s_lshl_b32 s66, s66, 11
    s_add_u32 s66, s66, 0x800000
    s_mov_b32 s61, s53
    s_and_b32 s61, s61, 7
    s_lshl3_add_u32 s67, s67, s61
    s_lshl_b32 s67, s67, 11
    s_add_u32 s67, s67, 0x800000
    s_mov_b32 s61, s53
    s_and_b32 s61, s61, 7
    s_lshl3_add_u32 s68, s68, s61
    s_lshl_b32 s68, s68, 11
    s_add_u32 s68, s68, 0x800000
    s_waitcnt lgkmcnt(0)
    s_mov_b32 s40, s18
    s_mov_b32 s41, s19
    s_mov_b32 s42, 0x1000000
    s_mov_b32 s43, 0x00020000
    s_mov_b32 s69, 0x1ff000
    buffer_load_dword v7, off, s[40:43], s69
    s_lshl3_add_u32 s64, s59, s53
    s_lshl_b32 s64, s64, 13
    s_add_u32 s60, s54, s55
    s_and_b32 s60, s60, 1
    s_lshl_b32 s60, s60, 12
    s_add_u32 s64, s64, s60
    s_xor_b32 s65, s64, 4096
    v_and_b32 v2, 31, v1
    v_bfe_u32 v3, v1, 1, 3
    v_lshrrev_b32 v4, 5, v1
    v_xor_b32 v3, v3, v4
    v_lshlrev_b32 v3, 4, v3
    v_lshl_add_u32 v2, v2, 7, v3
    s_lshl_b32 s56, s56, 12
    s_lshl_b32 s57, s52, 12
    s_add_u32 s57, s57, 147456
    s_lshl_b32 s60, s52, 13
    s_add_u32 s60, s60, 65536
    v_xor_b32 v3, 0, v2
    v_add_u32 v114, s56, v3
    v_add_u32 v118, s57, v3
    v_add_u32 v8, s60, v3
    v_xor_b32 v3, 32, v2
    v_add_u32 v115, s56, v3
    v_add_u32 v119, s57, v3
    v_add_u32 v9, s60, v3
    v_xor_b32 v3, 64, v2
    v_add_u32 v116, s56, v3
    v_add_u32 v120, s57, v3
    v_add_u32 v10, s60, v3
    v_xor_b32 v3, 96, v2
    v_add_u32 v117, s56, v3
    v_add_u32 v121, s57, v3
    v_add_u32 v11, s60, v3
    v_add_u32 v122, s57, v15
    v_bfe_u32 v2, v1, 2, 2
    v_lshl_add_u32 v4, v4, 3, v2
    v_bfe_u32 v3, v1, 4, 1
    v_lshlrev_b32 v3, 5, v3
    v_and_b32 v5, 1, v1
    v_lshl_add_u32 v3, v5, 4, v3
    v_bfe_u32 v5, v1, 1, 1
    v_lshl_add_u32 v3, v5, 3, v3
    v_lshl_add_u32 v14, v4, 6, v3
    v_lshl_add_u32 v12, v4, 7, v3
    v_bfe_u32 v5, v1, 3, 1
    v_lshl_add_u32 v12, v5, 6, v12
    v_xor_b32 v13, 64, v12
    v_lshl_add_u32 v3, v4, 8, v3
    s_lshl_b32 s58, s58, 1
    v_xor_b32 v5, s58, v2
    v_lshl_add_u32 v112, v5, 6, v3
    v_xor_b32 v113, 64, v112
    s_mov_b32 s100, 0xfffefffe
    s_mov_b32 s62, 8192
    s_barrier
    ds_read_b128 v[48:51], v114 offset:0
    ds_read_b64_tr_b16 v[16:17], v112 offset:8192
    ds_read_b64_tr_b16 v[18:19], v112 offset:9216
    ds_read_b64_tr_b16 v[20:21], v113 offset:8192
    ds_read_b64_tr_b16 v[22:23], v113 offset:9216
    ds_read_b128 v[52:55], v115 offset:0
    ds_read_b64_tr_b16 v[24:25], v112 offset:12288
    ds_read_b64_tr_b16 v[26:27], v112 offset:13312
    ds_read_b64_tr_b16 v[28:29], v113 offset:12288
    ds_read_b64_tr_b16 v[30:31], v113 offset:13312
    ds_read_b128 v[56:59], v116 offset:0
    ds_read_b64_tr_b16 v[32:33], v112 offset:16384
    ds_read_b64_tr_b16 v[34:35], v112 offset:17408
    s_waitcnt lgkmcnt(10)
    v_mfma_f32_32x32x16_bf16 v[208:223], v[16:19], v[48:51], 0
    ds_read_b64_tr_b16 v[36:37], v113 offset:16384
    ds_read_b64_tr_b16 v[38:39], v113 offset:17408
    s_waitcnt lgkmcnt(10)
    v_mfma_f32_32x32x16_bf16 v[224:239], v[20:23], v[48:51], 0
    ds_read_b128 v[60:63], v117 offset:0
    ds_read_b64_tr_b16 v[40:41], v112 offset:20480
    ds_read_b64_tr_b16 v[42:43], v112 offset:21504
    s_waitcnt lgkmcnt(10)
    v_mfma_f32_32x32x16_bf16 v[208:223], v[24:27], v[52:55], v[208:223]
    ds_read_b64_tr_b16 v[44:45], v113 offset:20480
    ds_read_b64_tr_b16 v[46:47], v113 offset:21504
    s_waitcnt lgkmcnt(10)
    v_mfma_f32_32x32x16_bf16 v[224:239], v[28:31], v[52:55], v[224:239]
    s_barrier
    ds_read_b128 v[48:51], v114 offset:24576
    ds_read_b64_tr_b16 v[16:17], v112 offset:32768
    ds_read_b64_tr_b16 v[18:19], v112 offset:33792
    s_waitcnt lgkmcnt(10)
    v_mfma_f32_32x32x16_bf16 v[208:223], v[32:35], v[56:59], v[208:223]
    ds_read_b64_tr_b16 v[20:21], v113 offset:32768
    ds_read_b64_tr_b16 v[22:23], v113 offset:33792
    s_waitcnt lgkmcnt(10)
    v_mfma_f32_32x32x16_bf16 v[224:239], v[36:39], v[56:59], v[224:239]
    ds_read_b128 v[52:55], v115 offset:24576
    ds_read_b64_tr_b16 v[24:25], v112 offset:36864
    ds_read_b64_tr_b16 v[26:27], v112 offset:37888
    s_waitcnt lgkmcnt(10)
    v_mfma_f32_32x32x16_bf16 v[208:223], v[40:43], v[60:63], v[208:223]
    ds_read_b64_tr_b16 v[28:29], v113 offset:36864
    ds_read_b64_tr_b16 v[30:31], v113 offset:37888
    s_waitcnt lgkmcnt(10)
    v_mfma_f32_32x32x16_bf16 v[224:239], v[44:47], v[60:63], v[224:239]
    ds_read_b128 v[56:59], v116 offset:24576
    ds_read_b64_tr_b16 v[32:33], v112 offset:40960
    ds_read_b64_tr_b16 v[34:35], v112 offset:41984
    s_waitcnt lgkmcnt(10)
    v_mfma_f32_32x32x16_bf16 v[208:223], v[16:19], v[48:51], v[208:223]
    ds_read_b64_tr_b16 v[36:37], v113 offset:40960
    ds_read_b64_tr_b16 v[38:39], v113 offset:41984
    s_waitcnt lgkmcnt(10)
    v_mfma_f32_32x32x16_bf16 v[224:239], v[20:23], v[48:51], v[224:239]
    ds_read_b128 v[60:63], v117 offset:24576
    ds_read_b64_tr_b16 v[40:41], v112 offset:45056
    ds_read_b64_tr_b16 v[42:43], v112 offset:46080
    s_waitcnt lgkmcnt(10)
    v_mfma_f32_32x32x16_bf16 v[208:223], v[24:27], v[52:55], v[208:223]
    ds_read_b64_tr_b16 v[44:45], v113 offset:45056
    ds_read_b64_tr_b16 v[46:47], v113 offset:46080
    s_waitcnt lgkmcnt(10)
    v_mfma_f32_32x32x16_bf16 v[224:239], v[28:31], v[52:55], v[224:239]
    s_barrier
    ds_read_b128 v[48:51], v114 offset:49152
    ds_read_b64_tr_b16 v[16:17], v112 offset:57344
    ds_read_b64_tr_b16 v[18:19], v112 offset:58368
    s_waitcnt lgkmcnt(10)
    v_mfma_f32_32x32x16_bf16 v[208:223], v[32:35], v[56:59], v[208:223]
    ds_read_b64_tr_b16 v[20:21], v113 offset:57344
    ds_read_b64_tr_b16 v[22:23], v113 offset:58368
    s_waitcnt lgkmcnt(10)
    v_mfma_f32_32x32x16_bf16 v[224:239], v[36:39], v[56:59], v[224:239]
    ds_read_b128 v[52:55], v115 offset:49152
    ds_read_b64_tr_b16 v[24:25], v112 offset:61440
    ds_read_b64_tr_b16 v[26:27], v112 offset:62464
    s_waitcnt lgkmcnt(10)
    v_mfma_f32_32x32x16_bf16 v[208:223], v[40:43], v[60:63], v[208:223]
    ds_read_b64_tr_b16 v[28:29], v113 offset:61440
    ds_read_b64_tr_b16 v[30:31], v113 offset:62464
    s_waitcnt lgkmcnt(10)
    v_mfma_f32_32x32x16_bf16 v[224:239], v[44:47], v[60:63], v[224:239]
    ds_read_b128 v[56:59], v116 offset:49152
    v_add_u32 v112, 65536, v112
    v_add_u32 v113, 65536, v113
    ds_read_b64_tr_b16 v[32:33], v112 offset:0
    ds_read_b64_tr_b16 v[34:35], v112 offset:1024
    s_waitcnt lgkmcnt(10)
    v_mfma_f32_32x32x16_bf16 v[208:223], v[16:19], v[48:51], v[208:223]
    ds_read_b64_tr_b16 v[36:37], v113 offset:0
    ds_read_b64_tr_b16 v[38:39], v113 offset:1024
    s_waitcnt lgkmcnt(10)
    v_mfma_f32_32x32x16_bf16 v[224:239], v[20:23], v[48:51], v[224:239]
    ds_read_b128 v[60:63], v117 offset:49152
    ds_read_b64_tr_b16 v[40:41], v112 offset:4096
    ds_read_b64_tr_b16 v[42:43], v112 offset:5120
    s_waitcnt lgkmcnt(10)
    v_mfma_f32_32x32x16_bf16 v[208:223], v[24:27], v[52:55], v[208:223]
    ds_read_b64_tr_b16 v[44:45], v113 offset:4096
    ds_read_b64_tr_b16 v[46:47], v113 offset:5120
    s_waitcnt lgkmcnt(10)
    v_mfma_f32_32x32x16_bf16 v[224:239], v[28:31], v[52:55], v[224:239]
    s_waitcnt vmcnt(0)
    s_barrier
    v_add_u32 v7, 0x11111111, v7
    v_and_b32 v2, 0xffff7777, v7
    v_or_b32 v2, 0x4444, v2
    v_and_b32 v6, 3, v1
    v_lshlrev_b32 v6, 2, v6
    v_lshrrev_b32 v2, v6, v2
    v_lshlrev_b32 v5, 12, v2
    v_and_b32 v5, 0x80008000, v5
    v_lshlrev_b32 v4, 13, v2
    v_and_b32 v4, 0x80008000, v4
    v_lshlrev_b32 v3, 14, v2
    v_and_b32 v3, 0x80008000, v3
    v_lshlrev_b32 v2, 15, v2
    v_and_b32 v2, 0x80008000, v2
    v_add_u32 v114, 65536, v114
    v_add_u32 v115, 65536, v115
    v_add_u32 v116, 65536, v116
    v_add_u32 v117, 65536, v117
    ds_read_b128 v[48:51], v114 offset:8192
    ds_read_b64_tr_b16 v[16:17], v112 offset:16384
    ds_read_b64_tr_b16 v[18:19], v112 offset:17408
    s_waitcnt lgkmcnt(10)
    v_mfma_f32_32x32x16_bf16 v[208:223], v[32:35], v[56:59], v[208:223]
    ds_read_b64_tr_b16 v[20:21], v113 offset:16384
    ds_read_b64_tr_b16 v[22:23], v113 offset:17408
    s_waitcnt lgkmcnt(10)
    v_mfma_f32_32x32x16_bf16 v[224:239], v[36:39], v[56:59], v[224:239]
    ds_read_b128 v[52:55], v115 offset:8192
    ds_read_b64_tr_b16 v[24:25], v112 offset:20480
    ds_read_b64_tr_b16 v[26:27], v112 offset:21504
    s_waitcnt lgkmcnt(10)
    v_mfma_f32_32x32x16_bf16 v[208:223], v[40:43], v[60:63], v[208:223]
    ds_read_b64_tr_b16 v[28:29], v113 offset:20480
    ds_read_b64_tr_b16 v[30:31], v113 offset:21504
    s_waitcnt lgkmcnt(10)
    v_mfma_f32_32x32x16_bf16 v[224:239], v[44:47], v[60:63], v[224:239]
    ds_read_b128 v[56:59], v116 offset:8192
    ds_read_b64_tr_b16 v[32:33], v112 offset:24576
    ds_read_b64_tr_b16 v[34:35], v112 offset:25600
    s_waitcnt lgkmcnt(10)
    v_mfma_f32_32x32x16_bf16 v[208:223], v[16:19], v[48:51], v[208:223]
    ds_read_b64_tr_b16 v[36:37], v113 offset:24576
    ds_read_b64_tr_b16 v[38:39], v113 offset:25600
    s_waitcnt lgkmcnt(10)
    v_mfma_f32_32x32x16_bf16 v[224:239], v[20:23], v[48:51], v[224:239]
    ds_read_b128 v[60:63], v117 offset:8192
    ds_read_b64_tr_b16 v[40:41], v112 offset:28672
    ds_read_b64_tr_b16 v[42:43], v112 offset:29696
    s_waitcnt lgkmcnt(10)
    v_mfma_f32_32x32x16_bf16 v[208:223], v[24:27], v[52:55], v[208:223]
    ds_read_b64_tr_b16 v[44:45], v113 offset:28672
    ds_read_b64_tr_b16 v[46:47], v113 offset:29696
    s_waitcnt lgkmcnt(10)
    v_mfma_f32_32x32x16_bf16 v[224:239], v[28:31], v[52:55], v[224:239]
    s_barrier
    ds_read_b128 v[48:51], v114 offset:32768
    ds_read_b64_tr_b16 v[16:17], v112 offset:40960
    ds_read_b64_tr_b16 v[18:19], v112 offset:41984
    s_waitcnt lgkmcnt(10)
    v_mfma_f32_32x32x16_bf16 v[208:223], v[32:35], v[56:59], v[208:223]
    ds_read_b64_tr_b16 v[20:21], v113 offset:40960
    ds_read_b64_tr_b16 v[22:23], v113 offset:41984
    s_waitcnt lgkmcnt(10)
    v_mfma_f32_32x32x16_bf16 v[224:239], v[36:39], v[56:59], v[224:239]
    ds_read_b128 v[52:55], v115 offset:32768
    ds_read_b64_tr_b16 v[24:25], v112 offset:45056
    ds_read_b64_tr_b16 v[26:27], v112 offset:46080
    s_waitcnt lgkmcnt(10)
    v_mfma_f32_32x32x16_bf16 v[208:223], v[40:43], v[60:63], v[208:223]
    ds_read_b64_tr_b16 v[28:29], v113 offset:45056
    ds_read_b64_tr_b16 v[30:31], v113 offset:46080
    s_waitcnt lgkmcnt(10)
    v_mfma_f32_32x32x16_bf16 v[224:239], v[44:47], v[60:63], v[224:239]
    ds_read_b128 v[56:59], v116 offset:32768
    v_subrev_u32 v112, 65536, v112
    v_subrev_u32 v113, 65536, v113
    ds_read_b64_tr_b16 v[32:33], v112 offset:0
    ds_read_b64_tr_b16 v[34:35], v112 offset:1024
    s_waitcnt lgkmcnt(10)
    v_mfma_f32_32x32x16_bf16 v[208:223], v[16:19], v[48:51], v[208:223]
    ds_read_b64_tr_b16 v[36:37], v113 offset:0
    ds_read_b64_tr_b16 v[38:39], v113 offset:1024
    s_waitcnt lgkmcnt(10)
    v_mfma_f32_32x32x16_bf16 v[224:239], v[20:23], v[48:51], v[224:239]
    ds_read_b128 v[60:63], v117 offset:32768
    ds_read_b64_tr_b16 v[40:41], v112 offset:4096
    ds_read_b64_tr_b16 v[42:43], v112 offset:5120
    s_waitcnt lgkmcnt(10)
    v_mfma_f32_32x32x16_bf16 v[208:223], v[24:27], v[52:55], v[208:223]
    ds_read_b64_tr_b16 v[44:45], v113 offset:4096
    ds_read_b64_tr_b16 v[46:47], v113 offset:5120
    s_waitcnt lgkmcnt(10)
    v_mfma_f32_32x32x16_bf16 v[224:239], v[28:31], v[52:55], v[224:239]
    s_barrier
    v_subrev_u32 v114, 65536, v114
    v_subrev_u32 v115, 65536, v115
    v_subrev_u32 v116, 65536, v116
    v_subrev_u32 v117, 65536, v117
    ds_read_b128 v[48:51], v114 offset:8192
    ds_read_b64_tr_b16 v[16:17], v112 offset:16384
    ds_read_b64_tr_b16 v[18:19], v112 offset:17408
    s_waitcnt lgkmcnt(10)
    v_mfma_f32_32x32x16_bf16 v[208:223], v[32:35], v[56:59], v[208:223]
    ds_read_b64_tr_b16 v[20:21], v113 offset:16384
    ds_read_b64_tr_b16 v[22:23], v113 offset:17408
    ds_read_b128 v[64:67], v118 offset:0
    s_waitcnt lgkmcnt(11)
    v_mfma_f32_32x32x16_bf16 v[224:239], v[36:39], v[56:59], v[224:239]
    ds_read_b128 v[52:55], v115 offset:8192
    ds_read_b64_tr_b16 v[24:25], v112 offset:20480
    ds_read_b64_tr_b16 v[26:27], v112 offset:21504
    s_waitcnt lgkmcnt(11)
    v_mfma_f32_32x32x16_bf16 v[208:223], v[40:43], v[60:63], v[208:223]
    ds_read_b64_tr_b16 v[28:29], v113 offset:20480
    ds_read_b64_tr_b16 v[30:31], v113 offset:21504
    ds_read_b128 v[68:71], v119 offset:0
    s_waitcnt lgkmcnt(12)
    v_mfma_f32_32x32x16_bf16 v[224:239], v[44:47], v[60:63], v[224:239]
    ds_read_b128 v[56:59], v116 offset:8192
    ds_read_b64_tr_b16 v[32:33], v112 offset:24576
    ds_read_b64_tr_b16 v[34:35], v112 offset:25600
    s_waitcnt lgkmcnt(12)
    v_mfma_f32_32x32x16_bf16 v[208:223], v[16:19], v[48:51], v[208:223]
    ds_read_b64_tr_b16 v[36:37], v113 offset:24576
    ds_read_b64_tr_b16 v[38:39], v113 offset:25600
    ds_read_b128 v[72:75], v120 offset:0
    s_waitcnt lgkmcnt(12)
    v_mfma_f32_32x32x16_bf16 v[224:239], v[20:23], v[48:51], v[224:239]
    ds_read_b128 v[60:63], v117 offset:8192
    ds_read_b64_tr_b16 v[40:41], v112 offset:28672
    ds_read_b64_tr_b16 v[42:43], v112 offset:29696
    s_waitcnt lgkmcnt(12)
    v_mfma_f32_32x32x16_bf16 v[208:223], v[24:27], v[52:55], v[208:223]
    ds_read_b64_tr_b16 v[44:45], v113 offset:28672
    ds_read_b64_tr_b16 v[46:47], v113 offset:29696
    ds_read_b128 v[76:79], v121 offset:0
    s_waitcnt lgkmcnt(12)
    v_mfma_f32_32x32x16_bf16 v[224:239], v[28:31], v[52:55], v[224:239]
    s_barrier
    ds_read_b128 v[48:51], v114 offset:32768
    ds_read_b64_tr_b16 v[16:17], v112 offset:40960
    ds_read_b64_tr_b16 v[18:19], v112 offset:41984
    s_waitcnt lgkmcnt(12)
    v_mfma_f32_32x32x16_bf16 v[208:223], v[32:35], v[56:59], v[208:223]
    ds_read_b64_tr_b16 v[20:21], v113 offset:40960
    ds_read_b64_tr_b16 v[22:23], v113 offset:41984
    s_waitcnt lgkmcnt(11)
    v_mfma_f32_32x32x16_bf16 v[224:239], v[36:39], v[56:59], v[224:239]
    ds_read_b128 v[52:55], v115 offset:32768
    ds_read_b64_tr_b16 v[24:25], v112 offset:45056
    ds_read_b64_tr_b16 v[26:27], v112 offset:46080
    s_waitcnt lgkmcnt(11)
    v_mfma_f32_32x32x16_bf16 v[208:223], v[40:43], v[60:63], v[208:223]
    ds_read_b64_tr_b16 v[28:29], v113 offset:45056
    ds_read_b64_tr_b16 v[30:31], v113 offset:46080
    s_waitcnt lgkmcnt(10)
    v_mfma_f32_32x32x16_bf16 v[224:239], v[44:47], v[60:63], v[224:239]
    ds_read_b128 v[56:59], v116 offset:32768
    ds_read_b64_tr_b16 v[32:33], v112 offset:49152
    ds_read_b64_tr_b16 v[34:35], v112 offset:50176
    s_waitcnt lgkmcnt(10)
    v_mfma_f32_32x32x16_bf16 v[208:223], v[16:19], v[48:51], v[208:223]
    ds_read_b64_tr_b16 v[36:37], v113 offset:49152
    ds_read_b64_tr_b16 v[38:39], v113 offset:50176
    s_waitcnt lgkmcnt(10)
    v_mfma_f32_32x32x16_bf16 v[224:239], v[20:23], v[48:51], v[224:239]
    ds_read_b128 v[60:63], v117 offset:32768
    ds_read_b64_tr_b16 v[40:41], v112 offset:53248
    ds_read_b64_tr_b16 v[42:43], v112 offset:54272
    s_waitcnt lgkmcnt(10)
    v_mfma_f32_32x32x16_bf16 v[208:223], v[24:27], v[52:55], v[208:223]
    ds_read_b64_tr_b16 v[44:45], v113 offset:53248
    ds_read_b64_tr_b16 v[46:47], v113 offset:54272
    s_waitcnt lgkmcnt(10)
    v_mfma_f32_32x32x16_bf16 v[224:239], v[28:31], v[52:55], v[224:239]
    s_barrier
    ds_read_b128 v[48:51], v114 offset:57344
    v_add_u32 v112, 65536, v112
    v_add_u32 v113, 65536, v113
    ds_read_b64_tr_b16 v[16:17], v112 offset:0
    ds_read_b64_tr_b16 v[18:19], v112 offset:1024
    s_waitcnt lgkmcnt(10)
    v_mfma_f32_32x32x16_bf16 v[208:223], v[32:35], v[56:59], v[208:223]
    ds_read_b64_tr_b16 v[20:21], v113 offset:0
    ds_read_b64_tr_b16 v[22:23], v113 offset:1024
    s_waitcnt lgkmcnt(10)
    v_mfma_f32_32x32x16_bf16 v[224:239], v[36:39], v[56:59], v[224:239]
    ds_read_b128 v[52:55], v115 offset:57344
    ds_read_b64_tr_b16 v[24:25], v112 offset:4096
    ds_read_b64_tr_b16 v[26:27], v112 offset:5120
    s_waitcnt lgkmcnt(10)
    v_mfma_f32_32x32x16_bf16 v[208:223], v[40:43], v[60:63], v[208:223]
    ds_read_b64_tr_b16 v[28:29], v113 offset:4096
    ds_read_b64_tr_b16 v[30:31], v113 offset:5120
    s_waitcnt lgkmcnt(10)
    v_mfma_f32_32x32x16_bf16 v[224:239], v[44:47], v[60:63], v[224:239]
    ds_read_b128 v[56:59], v116 offset:57344
    ds_read_b64_tr_b16 v[32:33], v112 offset:8192
    ds_read_b64_tr_b16 v[34:35], v112 offset:9216
    s_waitcnt lgkmcnt(10)
    v_mfma_f32_32x32x16_bf16 v[208:223], v[16:19], v[48:51], v[208:223]
    ds_read_b64_tr_b16 v[36:37], v113 offset:8192
    ds_read_b64_tr_b16 v[38:39], v113 offset:9216
    s_waitcnt lgkmcnt(10)
    v_mfma_f32_32x32x16_bf16 v[224:239], v[20:23], v[48:51], v[224:239]
    ds_read_b128 v[60:63], v117 offset:57344
    ds_read_b64_tr_b16 v[40:41], v112 offset:12288
    ds_read_b64_tr_b16 v[42:43], v112 offset:13312
    s_waitcnt lgkmcnt(10)
    v_mfma_f32_32x32x16_bf16 v[208:223], v[24:27], v[52:55], v[208:223]
    ds_read_b64_tr_b16 v[44:45], v113 offset:12288
    ds_read_b64_tr_b16 v[46:47], v113 offset:13312
    s_waitcnt lgkmcnt(10)
    v_mfma_f32_32x32x16_bf16 v[224:239], v[28:31], v[52:55], v[224:239]
    s_barrier
    v_add_u32 v114, 65536, v114
    v_add_u32 v115, 65536, v115
    v_add_u32 v116, 65536, v116
    v_add_u32 v117, 65536, v117
    ds_read_b128 v[48:51], v114 offset:16384
    ds_read_b64_tr_b16 v[16:17], v112 offset:24576
    ds_read_b64_tr_b16 v[18:19], v112 offset:25600
    s_waitcnt lgkmcnt(10)
    v_mfma_f32_32x32x16_bf16 v[208:223], v[32:35], v[56:59], v[208:223]
    ds_read_b64_tr_b16 v[20:21], v113 offset:24576
    ds_read_b64_tr_b16 v[22:23], v113 offset:25600
    s_waitcnt lgkmcnt(10)
    v_mfma_f32_32x32x16_bf16 v[224:239], v[36:39], v[56:59], v[224:239]
    ds_read_b128 v[52:55], v115 offset:16384
    ds_read_b64_tr_b16 v[24:25], v112 offset:28672
    ds_read_b64_tr_b16 v[26:27], v112 offset:29696
    s_waitcnt lgkmcnt(10)
    v_mfma_f32_32x32x16_bf16 v[208:223], v[40:43], v[60:63], v[208:223]
    ds_read_b64_tr_b16 v[28:29], v113 offset:28672
    ds_read_b64_tr_b16 v[30:31], v113 offset:29696
    s_waitcnt lgkmcnt(10)
    v_mfma_f32_32x32x16_bf16 v[224:239], v[44:47], v[60:63], v[224:239]
    ds_read_b128 v[56:59], v116 offset:16384
    s_barrier
    ds_read_b64_tr_b16 v[32:33], v112 offset:32768
    ds_read_b64_tr_b16 v[34:35], v112 offset:33792
    s_waitcnt lgkmcnt(10)
    v_mfma_f32_32x32x16_bf16 v[208:223], v[16:19], v[48:51], v[208:223]
    ds_read_b128 v[60:63], v117 offset:16384
    ds_read_b64_tr_b16 v[36:37], v112 offset:36864
    ds_read_b64_tr_b16 v[38:39], v112 offset:37888
    s_waitcnt lgkmcnt(11)
    v_mfma_f32_32x32x16_bf16 v[224:239], v[20:23], v[48:51], v[224:239]
    ds_read_b64_tr_b16 v[40:41], v113 offset:32768
    ds_read_b64_tr_b16 v[42:43], v113 offset:33792
    s_waitcnt lgkmcnt(10)
    v_mfma_f32_32x32x16_bf16 v[208:223], v[24:27], v[52:55], v[208:223]
    ds_read_b64_tr_b16 v[44:45], v113 offset:36864
    ds_read_b64_tr_b16 v[46:47], v113 offset:37888
    s_waitcnt lgkmcnt(10)
    v_mfma_f32_32x32x16_bf16 v[224:239], v[28:31], v[52:55], v[224:239]
    s_waitcnt lgkmcnt(7)
    v_mfma_f32_32x32x16_bf16 v[208:223], v[32:35], v[56:59], v[208:223]
    s_waitcnt lgkmcnt(4)
    v_mfma_f32_32x32x16_bf16 v[208:223], v[36:39], v[60:63], v[208:223]
    s_nop 4
    s_waitcnt lgkmcnt(2)
    v_mfma_f32_32x32x16_bf16 v[224:239], v[40:43], v[56:59], v[224:239]
    s_nop 4
    s_waitcnt lgkmcnt(0)
    v_mfma_f32_32x32x16_bf16 v[224:239], v[44:47], v[60:63], v[224:239]
    v_cvt_pk_bf16_f32 v208, v208, v209
    v_cvt_pk_bf16_f32 v209, v210, v211
    v_cvt_pk_bf16_f32 v210, v212, v213
    v_cvt_pk_bf16_f32 v211, v214, v215
    v_cvt_pk_bf16_f32 v212, v216, v217
    v_cvt_pk_bf16_f32 v213, v218, v219
    v_cvt_pk_bf16_f32 v214, v220, v221
    v_cvt_pk_bf16_f32 v215, v222, v223
    v_mfma_f32_32x32x16_bf16 v[240:255], v[64:67], v[208:211], 0
    s_nop 2
    v_cvt_pk_bf16_f32 v224, v224, v225
    v_cvt_pk_bf16_f32 v225, v226, v227
    v_cvt_pk_bf16_f32 v226, v228, v229
    v_cvt_pk_bf16_f32 v227, v230, v231
    v_mfma_f32_32x32x16_bf16 v[240:255], v[68:71], v[212:215], v[240:255]
    v_cvt_pk_bf16_f32 v228, v232, v233
    v_cvt_pk_bf16_f32 v229, v234, v235
    v_cvt_pk_bf16_f32 v230, v236, v237
    v_cvt_pk_bf16_f32 v231, v238, v239
    v_mfma_f32_32x32x16_bf16 v[240:255], v[72:75], v[224:227], v[240:255]
    s_nop 1
    v_mfma_f32_32x32x16_bf16 v[240:255], v[76:79], v[228:231], v[240:255]
    s_nop 11
    ds_write_b128 v122, v[240:243] offset:0
    ds_write_b128 v122, v[244:247] offset:1024
    ds_write_b128 v122, v[248:251] offset:2048
    ds_write_b128 v122, v[252:255] offset:3072
    s_waitcnt lgkmcnt(0)
    s_barrier
    s_cmp_ge_u32 s2, 192
    s_cbranch_scc1 L_upd
    ds_read_b128 v[48:51], v8 offset:49152
    v_add_u32 v12, 65536, v12
    v_add_u32 v13, 65536, v13
    ds_read_b64_tr_b16 v[16:17], v12 offset:40960
    ds_read_b64_tr_b16 v[18:19], v12 offset:41472
    ds_read_b64_tr_b16 v[20:21], v13 offset:40960
    ds_read_b64_tr_b16 v[22:23], v13 offset:41472
    ds_read_b128 v[52:55], v9 offset:49152
    ds_read_b64_tr_b16 v[24:25], v12 offset:43008
    ds_read_b64_tr_b16 v[26:27], v12 offset:43520
    ds_read_b64_tr_b16 v[28:29], v13 offset:43008
    ds_read_b64_tr_b16 v[30:31], v13 offset:43520
    ds_read_b128 v[56:59], v10 offset:49152
    ds_read_b64_tr_b16 v[32:33], v12 offset:45056
    ds_read_b64_tr_b16 v[34:35], v12 offset:45568
    s_waitcnt lgkmcnt(10)
    v_mfma_f32_32x32x16_bf16 v[208:223], v[48:51], v[16:19], 0
    ds_read_b64_tr_b16 v[36:37], v13 offset:45056
    ds_read_b64_tr_b16 v[38:39], v13 offset:45568
    s_waitcnt lgkmcnt(10)
    v_mfma_f32_32x32x16_bf16 v[224:239], v[48:51], v[20:23], 0
    ds_read_b128 v[60:63], v11 offset:49152
    ds_read_b64_tr_b16 v[40:41], v12 offset:47104
    ds_read_b64_tr_b16 v[42:43], v12 offset:47616
    s_waitcnt lgkmcnt(10)
    v_mfma_f32_32x32x16_bf16 v[208:223], v[52:55], v[24:27], v[208:223]
    ds_read_b64_tr_b16 v[44:45], v13 offset:47104
    ds_read_b64_tr_b16 v[46:47], v13 offset:47616
    s_waitcnt lgkmcnt(10)
    v_mfma_f32_32x32x16_bf16 v[224:239], v[52:55], v[28:31], v[224:239]
    ds_read_b128 v[64:67], v8 offset:53248
    s_barrier
    v_subrev_u32 v12, 65536, v12
    v_subrev_u32 v13, 65536, v13
    ds_read_b64_tr_b16 v[16:17], v12 offset:0
    ds_read_b64_tr_b16 v[18:19], v12 offset:512
    s_waitcnt lgkmcnt(10)
    v_mfma_f32_32x32x16_bf16 v[208:223], v[56:59], v[32:35], v[208:223]
    ds_read_b64_tr_b16 v[20:21], v13 offset:0
    ds_read_b64_tr_b16 v[22:23], v13 offset:512
    s_waitcnt lgkmcnt(10)
    v_mfma_f32_32x32x16_bf16 v[224:239], v[56:59], v[36:39], v[224:239]
    ds_read_b128 v[68:71], v9 offset:53248
    ds_read_b64_tr_b16 v[24:25], v12 offset:2048
    ds_read_b64_tr_b16 v[26:27], v12 offset:2560
    s_waitcnt lgkmcnt(10)
    v_mfma_f32_32x32x16_bf16 v[208:223], v[60:63], v[40:43], v[208:223]
    ds_read_b64_tr_b16 v[28:29], v13 offset:2048
    ds_read_b64_tr_b16 v[30:31], v13 offset:2560
    s_waitcnt lgkmcnt(10)
    v_mfma_f32_32x32x16_bf16 v[224:239], v[60:63], v[44:47], v[224:239]
    ds_read_b128 v[72:75], v10 offset:53248
    ds_read_b64_tr_b16 v[32:33], v12 offset:4096
    ds_read_b64_tr_b16 v[34:35], v12 offset:4608
    s_waitcnt lgkmcnt(10)
    v_mfma_f32_32x32x16_bf16 v[208:223], v[64:67], v[16:19], v[208:223]
    ds_read_b64_tr_b16 v[36:37], v13 offset:4096
    ds_read_b64_tr_b16 v[38:39], v13 offset:4608
    s_waitcnt lgkmcnt(10)
    v_mfma_f32_32x32x16_bf16 v[224:239], v[64:67], v[20:23], v[224:239]
    ds_read_b128 v[76:79], v11 offset:53248
    ds_read_b64_tr_b16 v[40:41], v12 offset:6144
    ds_read_b64_tr_b16 v[42:43], v12 offset:6656
    s_waitcnt lgkmcnt(10)
    v_mfma_f32_32x32x16_bf16 v[208:223], v[68:71], v[24:27], v[208:223]
    ds_read_b64_tr_b16 v[44:45], v13 offset:6144
    ds_read_b64_tr_b16 v[46:47], v13 offset:6656
    s_waitcnt lgkmcnt(10)
    v_mfma_f32_32x32x16_bf16 v[224:239], v[68:71], v[28:31], v[224:239]
    s_barrier
    ds_read_b64_tr_b16 v[16:17], v14 offset:8192
    ds_read_b64_tr_b16 v[18:19], v14 offset:8448
    s_waitcnt lgkmcnt(9)
    v_mfma_f32_32x32x16_bf16 v[208:223], v[72:75], v[32:35], v[208:223]
    ds_read_b64_tr_b16 v[20:21], v14 offset:9216
    ds_read_b64_tr_b16 v[22:23], v14 offset:9472
    s_waitcnt lgkmcnt(9)
    v_mfma_f32_32x32x16_bf16 v[224:239], v[72:75], v[36:39], v[224:239]
    ds_read_b64_tr_b16 v[24:25], v14 offset:10240
    ds_read_b64_tr_b16 v[26:27], v14 offset:10496
    s_waitcnt lgkmcnt(8)
    v_mfma_f32_32x32x16_bf16 v[208:223], v[76:79], v[40:43], v[208:223]
    ds_read_b64_tr_b16 v[28:29], v14 offset:11264
    ds_read_b64_tr_b16 v[30:31], v14 offset:11520
    s_waitcnt lgkmcnt(8)
    v_mfma_f32_32x32x16_bf16 v[224:239], v[76:79], v[44:47], v[224:239]
    ds_read_b64_tr_b16 v[32:33], v14 offset:12288
    ds_read_b64_tr_b16 v[34:35], v14 offset:12544
    s_waitcnt lgkmcnt(8)
    v_mfma_f32_32x32x16_bf16 v[240:255], v[48:51], v[16:19], 0
    ds_read_b64_tr_b16 v[36:37], v14 offset:13312
    ds_read_b64_tr_b16 v[38:39], v14 offset:13568
    s_waitcnt lgkmcnt(8)
    v_mfma_f32_32x32x16_bf16 v[240:255], v[52:55], v[20:23], v[240:255]
    ds_read_b64_tr_b16 v[40:41], v14 offset:14336
    ds_read_b64_tr_b16 v[42:43], v14 offset:14592
    s_waitcnt lgkmcnt(8)
    v_mfma_f32_32x32x16_bf16 v[240:255], v[56:59], v[24:27], v[240:255]
    ds_read_b64_tr_b16 v[44:45], v14 offset:15360
    ds_read_b64_tr_b16 v[46:47], v14 offset:15616
    v_cvt_pk_bf16_f32 v112, v208, v209
    v_cvt_pk_bf16_f32 v113, v210, v211
    v_cvt_pk_bf16_f32 v114, v212, v213
    v_cvt_pk_bf16_f32 v115, v214, v215
    s_waitcnt lgkmcnt(8)
    v_mfma_f32_32x32x16_bf16 v[240:255], v[60:63], v[28:31], v[240:255]
    s_barrier
    ds_read_b64_tr_b16 v[16:17], v12 offset:16384
    ds_read_b64_tr_b16 v[18:19], v12 offset:16896
    v_cvt_pk_bf16_f32 v116, v216, v217
    v_cvt_pk_bf16_f32 v117, v218, v219
    v_cvt_pk_bf16_f32 v118, v220, v221
    v_cvt_pk_bf16_f32 v119, v222, v223
    s_waitcnt lgkmcnt(8)
    v_mfma_f32_32x32x16_bf16 v[240:255], v[64:67], v[32:35], v[240:255]
    ds_read_b64_tr_b16 v[20:21], v13 offset:16384
    ds_read_b64_tr_b16 v[22:23], v13 offset:16896
    v_cvt_pk_bf16_f32 v120, v224, v225
    v_cvt_pk_bf16_f32 v121, v226, v227
    v_cvt_pk_bf16_f32 v122, v228, v229
    v_cvt_pk_bf16_f32 v123, v230, v231
    s_waitcnt lgkmcnt(8)
    v_mfma_f32_32x32x16_bf16 v[240:255], v[68:71], v[36:39], v[240:255]
    ds_read_b64_tr_b16 v[24:25], v12 offset:18432
    ds_read_b64_tr_b16 v[26:27], v12 offset:18944
    v_cvt_pk_bf16_f32 v124, v232, v233
    v_cvt_pk_bf16_f32 v125, v234, v235
    v_cvt_pk_bf16_f32 v126, v236, v237
    v_cvt_pk_bf16_f32 v127, v238, v239
    s_waitcnt lgkmcnt(8)
    v_mfma_f32_32x32x16_bf16 v[240:255], v[72:75], v[40:43], v[240:255]
    ds_read_b64_tr_b16 v[28:29], v13 offset:18432
    ds_read_b64_tr_b16 v[30:31], v13 offset:18944
    s_waitcnt lgkmcnt(8)
    v_mfma_f32_32x32x16_bf16 v[240:255], v[76:79], v[44:47], v[240:255]
    ds_read_b64_tr_b16 v[32:33], v12 offset:20480
    ds_read_b64_tr_b16 v[34:35], v12 offset:20992
    s_waitcnt lgkmcnt(8)
    v_mfma_f32_32x32x16_bf16 v[208:223], v[48:51], v[16:19], 0
    ds_read_b64_tr_b16 v[36:37], v13 offset:20480
    ds_read_b64_tr_b16 v[38:39], v13 offset:20992
    s_waitcnt lgkmcnt(8)
    v_mfma_f32_32x32x16_bf16 v[224:239], v[48:51], v[20:23], 0
    ds_read_b64_tr_b16 v[40:41], v12 offset:22528
    ds_read_b64_tr_b16 v[42:43], v12 offset:23040
    s_waitcnt lgkmcnt(8)
    v_mfma_f32_32x32x16_bf16 v[208:223], v[52:55], v[24:27], v[208:223]
    ds_read_b64_tr_b16 v[44:45], v13 offset:22528
    ds_read_b64_tr_b16 v[46:47], v13 offset:23040
    s_waitcnt lgkmcnt(8)
    v_mfma_f32_32x32x16_bf16 v[224:239], v[52:55], v[28:31], v[224:239]
    s_barrier
    ds_read_b64_tr_b16 v[16:17], v12 offset:24576
    ds_read_b64_tr_b16 v[18:19], v12 offset:25088
    v_cvt_pk_bf16_f32 v128, v240, v241
    v_cvt_pk_bf16_f32 v129, v242, v243
    v_cvt_pk_bf16_f32 v130, v244, v245
    v_cvt_pk_bf16_f32 v131, v246, v247
    s_waitcnt lgkmcnt(8)
    v_mfma_f32_32x32x16_bf16 v[208:223], v[56:59], v[32:35], v[208:223]
    ds_read_b64_tr_b16 v[20:21], v13 offset:24576
    ds_read_b64_tr_b16 v[22:23], v13 offset:25088
    v_cvt_pk_bf16_f32 v132, v248, v249
    v_cvt_pk_bf16_f32 v133, v250, v251
    v_cvt_pk_bf16_f32 v134, v252, v253
    v_cvt_pk_bf16_f32 v135, v254, v255
    s_waitcnt lgkmcnt(8)
    v_mfma_f32_32x32x16_bf16 v[224:239], v[56:59], v[36:39], v[224:239]
    ds_read_b64_tr_b16 v[24:25], v12 offset:26624
    ds_read_b64_tr_b16 v[26:27], v12 offset:27136
    s_waitcnt lgkmcnt(8)
    v_mfma_f32_32x32x16_bf16 v[208:223], v[60:63], v[40:43], v[208:223]
    ds_read_b64_tr_b16 v[28:29], v13 offset:26624
    ds_read_b64_tr_b16 v[30:31], v13 offset:27136
    s_waitcnt lgkmcnt(8)
    v_mfma_f32_32x32x16_bf16 v[224:239], v[60:63], v[44:47], v[224:239]
    ds_read_b64_tr_b16 v[32:33], v12 offset:28672
    ds_read_b64_tr_b16 v[34:35], v12 offset:29184
    s_waitcnt lgkmcnt(8)
    v_mfma_f32_32x32x16_bf16 v[208:223], v[64:67], v[16:19], v[208:223]
    ds_read_b64_tr_b16 v[36:37], v13 offset:28672
    ds_read_b64_tr_b16 v[38:39], v13 offset:29184
    s_waitcnt lgkmcnt(8)
    v_mfma_f32_32x32x16_bf16 v[224:239], v[64:67], v[20:23], v[224:239]
    ds_read_b64_tr_b16 v[40:41], v12 offset:30720
    ds_read_b64_tr_b16 v[42:43], v12 offset:31232
    s_waitcnt lgkmcnt(8)
    v_mfma_f32_32x32x16_bf16 v[208:223], v[68:71], v[24:27], v[208:223]
    ds_read_b64_tr_b16 v[44:45], v13 offset:30720
    ds_read_b64_tr_b16 v[46:47], v13 offset:31232
    s_waitcnt lgkmcnt(8)
    v_mfma_f32_32x32x16_bf16 v[224:239], v[68:71], v[28:31], v[224:239]
    s_barrier
    ds_read_b64_tr_b16 v[16:17], v14 offset:32768
    ds_read_b64_tr_b16 v[18:19], v14 offset:33024
    s_waitcnt lgkmcnt(8)
    v_mfma_f32_32x32x16_bf16 v[208:223], v[72:75], v[32:35], v[208:223]
    ds_read_b64_tr_b16 v[20:21], v14 offset:33792
    ds_read_b64_tr_b16 v[22:23], v14 offset:34048
    s_waitcnt lgkmcnt(8)
    v_mfma_f32_32x32x16_bf16 v[224:239], v[72:75], v[36:39], v[224:239]
    ds_read_b64_tr_b16 v[24:25], v14 offset:34816
    ds_read_b64_tr_b16 v[26:27], v14 offset:35072
    s_waitcnt lgkmcnt(8)
    v_mfma_f32_32x32x16_bf16 v[208:223], v[76:79], v[40:43], v[208:223]
    ds_read_b64_tr_b16 v[28:29], v14 offset:35840
    ds_read_b64_tr_b16 v[30:31], v14 offset:36096
    s_waitcnt lgkmcnt(8)
    v_mfma_f32_32x32x16_bf16 v[224:239], v[76:79], v[44:47], v[224:239]
    ds_read_b64_tr_b16 v[32:33], v14 offset:36864
    ds_read_b64_tr_b16 v[34:35], v14 offset:37120
    s_waitcnt lgkmcnt(8)
    v_mfma_f32_32x32x16_bf16 v[240:255], v[48:51], v[16:19], 0
    ds_read_b64_tr_b16 v[36:37], v14 offset:37888
    ds_read_b64_tr_b16 v[38:39], v14 offset:38144
    s_waitcnt lgkmcnt(8)
    v_mfma_f32_32x32x16_bf16 v[240:255], v[52:55], v[20:23], v[240:255]
    ds_read_b64_tr_b16 v[40:41], v14 offset:38912
    ds_read_b64_tr_b16 v[42:43], v14 offset:39168
    s_waitcnt lgkmcnt(8)
    v_mfma_f32_32x32x16_bf16 v[240:255], v[56:59], v[24:27], v[240:255]
    ds_read_b64_tr_b16 v[44:45], v14 offset:39936
    ds_read_b64_tr_b16 v[46:47], v14 offset:40192
    v_cvt_pk_bf16_f32 v136, v208, v209
    v_cvt_pk_bf16_f32 v137, v210, v211
    v_cvt_pk_bf16_f32 v138, v212, v213
    v_cvt_pk_bf16_f32 v139, v214, v215
    s_waitcnt lgkmcnt(8)
    v_mfma_f32_32x32x16_bf16 v[240:255], v[60:63], v[28:31], v[240:255]
    s_barrier
    v_subrev_u32 v8, 65536, v8
    v_subrev_u32 v9, 65536, v9
    v_subrev_u32 v10, 65536, v10
    v_subrev_u32 v11, 65536, v11
    ds_read_b128 v[48:51], v8 offset:40960
    v_add_u32 v12, 65536, v12
    v_add_u32 v13, 65536, v13
    ds_read_b64_tr_b16 v[16:17], v12 offset:8192
    ds_read_b64_tr_b16 v[18:19], v12 offset:8704
    v_cvt_pk_bf16_f32 v140, v216, v217
    v_cvt_pk_bf16_f32 v141, v218, v219
    v_cvt_pk_bf16_f32 v142, v220, v221
    v_cvt_pk_bf16_f32 v143, v222, v223
    s_waitcnt lgkmcnt(9)
    v_mfma_f32_32x32x16_bf16 v[240:255], v[64:67], v[32:35], v[240:255]
    ds_read_b64_tr_b16 v[20:21], v13 offset:8192
    ds_read_b64_tr_b16 v[22:23], v13 offset:8704
    v_cvt_pk_bf16_f32 v144, v224, v225
    v_cvt_pk_bf16_f32 v145, v226, v227
    v_cvt_pk_bf16_f32 v146, v228, v229
    v_cvt_pk_bf16_f32 v147, v230, v231
    s_waitcnt lgkmcnt(9)
    v_mfma_f32_32x32x16_bf16 v[240:255], v[68:71], v[36:39], v[240:255]
    ds_read_b128 v[52:55], v9 offset:40960
    ds_read_b64_tr_b16 v[24:25], v12 offset:10240
    ds_read_b64_tr_b16 v[26:27], v12 offset:10752
    v_cvt_pk_bf16_f32 v148, v232, v233
    v_cvt_pk_bf16_f32 v149, v234, v235
    v_cvt_pk_bf16_f32 v150, v236, v237
    v_cvt_pk_bf16_f32 v151, v238, v239
    s_waitcnt lgkmcnt(10)
    v_mfma_f32_32x32x16_bf16 v[240:255], v[72:75], v[40:43], v[240:255]
    ds_read_b64_tr_b16 v[28:29], v13 offset:10240
    ds_read_b64_tr_b16 v[30:31], v13 offset:10752
    s_waitcnt lgkmcnt(10)
    v_mfma_f32_32x32x16_bf16 v[240:255], v[76:79], v[44:47], v[240:255]
    ds_read_b128 v[56:59], v10 offset:40960
    ds_read_b64_tr_b16 v[32:33], v12 offset:12288
    ds_read_b64_tr_b16 v[34:35], v12 offset:12800
    s_waitcnt lgkmcnt(10)
    v_mfma_f32_32x32x16_bf16 v[208:223], v[48:51], v[16:19], 0
    ds_read_b64_tr_b16 v[36:37], v13 offset:12288
    ds_read_b64_tr_b16 v[38:39], v13 offset:12800
    s_waitcnt lgkmcnt(10)
    v_mfma_f32_32x32x16_bf16 v[224:239], v[48:51], v[20:23], 0
    ds_read_b128 v[60:63], v11 offset:40960
    ds_read_b64_tr_b16 v[40:41], v12 offset:14336
    ds_read_b64_tr_b16 v[42:43], v12 offset:14848
    s_waitcnt lgkmcnt(10)
    v_mfma_f32_32x32x16_bf16 v[208:223], v[52:55], v[24:27], v[208:223]
    ds_read_b64_tr_b16 v[44:45], v13 offset:14336
    ds_read_b64_tr_b16 v[46:47], v13 offset:14848
    s_waitcnt lgkmcnt(10)
    v_mfma_f32_32x32x16_bf16 v[224:239], v[52:55], v[28:31], v[224:239]
    ds_read_b128 v[64:67], v8 offset:45056
    s_barrier
    ds_read_b64_tr_b16 v[16:17], v12 offset:16384
    ds_read_b64_tr_b16 v[18:19], v12 offset:16896
    v_cvt_pk_bf16_f32 v152, v240, v241
    v_cvt_pk_bf16_f32 v153, v242, v243
    v_cvt_pk_bf16_f32 v154, v244, v245
    v_cvt_pk_bf16_f32 v155, v246, v247
    s_waitcnt lgkmcnt(10)
    v_mfma_f32_32x32x16_bf16 v[208:223], v[56:59], v[32:35], v[208:223]
    ds_read_b64_tr_b16 v[20:21], v13 offset:16384
    ds_read_b64_tr_b16 v[22:23], v13 offset:16896
    v_cvt_pk_bf16_f32 v156, v248, v249
    v_cvt_pk_bf16_f32 v157, v250, v251
    v_cvt_pk_bf16_f32 v158, v252, v253
    v_cvt_pk_bf16_f32 v159, v254, v255
    s_waitcnt lgkmcnt(10)
    v_mfma_f32_32x32x16_bf16 v[224:239], v[56:59], v[36:39], v[224:239]
    ds_read_b128 v[68:71], v9 offset:45056
    ds_read_b64_tr_b16 v[24:25], v12 offset:18432
    ds_read_b64_tr_b16 v[26:27], v12 offset:18944
    s_waitcnt lgkmcnt(10)
    v_mfma_f32_32x32x16_bf16 v[208:223], v[60:63], v[40:43], v[208:223]
    ds_read_b64_tr_b16 v[28:29], v13 offset:18432
    ds_read_b64_tr_b16 v[30:31], v13 offset:18944
    s_waitcnt lgkmcnt(10)
    v_mfma_f32_32x32x16_bf16 v[224:239], v[60:63], v[44:47], v[224:239]
    ds_read_b128 v[72:75], v10 offset:45056
    ds_read_b64_tr_b16 v[32:33], v12 offset:20480
    ds_read_b64_tr_b16 v[34:35], v12 offset:20992
    s_waitcnt lgkmcnt(10)
    v_mfma_f32_32x32x16_bf16 v[208:223], v[64:67], v[16:19], v[208:223]
    ds_read_b64_tr_b16 v[36:37], v13 offset:20480
    ds_read_b64_tr_b16 v[38:39], v13 offset:20992
    s_waitcnt lgkmcnt(10)
    v_mfma_f32_32x32x16_bf16 v[224:239], v[64:67], v[20:23], v[224:239]
    ds_read_b128 v[76:79], v11 offset:45056
    ds_read_b64_tr_b16 v[40:41], v12 offset:22528
    ds_read_b64_tr_b16 v[42:43], v12 offset:23040
    s_waitcnt lgkmcnt(10)
    v_mfma_f32_32x32x16_bf16 v[208:223], v[68:71], v[24:27], v[208:223]
    ds_read_b64_tr_b16 v[44:45], v13 offset:22528
    ds_read_b64_tr_b16 v[46:47], v13 offset:23040
    s_waitcnt lgkmcnt(10)
    v_mfma_f32_32x32x16_bf16 v[224:239], v[68:71], v[28:31], v[224:239]
    v_add_u32 v14, 65536, v14
    ds_read_b64_tr_b16 v[16:17], v14 offset:24576
    ds_read_b64_tr_b16 v[18:19], v14 offset:24832
    s_waitcnt lgkmcnt(9)
    v_mfma_f32_32x32x16_bf16 v[208:223], v[72:75], v[32:35], v[208:223]
    ds_read_b64_tr_b16 v[20:21], v14 offset:25600
    ds_read_b64_tr_b16 v[22:23], v14 offset:25856
    buffer_load_dwordx4 v[80:83], v15, s[40:43], s64 offen offset:0 sc1
    s_waitcnt lgkmcnt(9)
    v_mfma_f32_32x32x16_bf16 v[224:239], v[72:75], v[36:39], v[224:239]
    ds_read_b64_tr_b16 v[24:25], v14 offset:26624
    ds_read_b64_tr_b16 v[26:27], v14 offset:26880
    s_waitcnt lgkmcnt(8)
    v_mfma_f32_32x32x16_bf16 v[208:223], v[76:79], v[40:43], v[208:223]
    ds_read_b64_tr_b16 v[28:29], v14 offset:27648
    ds_read_b64_tr_b16 v[30:31], v14 offset:27904
    buffer_load_dwordx4 v[84:87], v15, s[40:43], s64 offen offset:1024 sc1
    s_waitcnt lgkmcnt(8)
    v_mfma_f32_32x32x16_bf16 v[224:239], v[76:79], v[44:47], v[224:239]
    ds_read_b64_tr_b16 v[32:33], v14 offset:28672
    ds_read_b64_tr_b16 v[34:35], v14 offset:28928
    s_waitcnt lgkmcnt(8)
    v_mfma_f32_32x32x16_bf16 v[240:255], v[48:51], v[16:19], 0
    ds_read_b64_tr_b16 v[36:37], v14 offset:29696
    ds_read_b64_tr_b16 v[38:39], v14 offset:29952
    buffer_load_dwordx4 v[88:91], v15, s[40:43], s64 offen offset:2048 sc1
    s_waitcnt lgkmcnt(8)
    v_mfma_f32_32x32x16_bf16 v[240:255], v[52:55], v[20:23], v[240:255]
    ds_read_b64_tr_b16 v[40:41], v14 offset:30720
    ds_read_b64_tr_b16 v[42:43], v14 offset:30976
    s_waitcnt lgkmcnt(8)
    v_mfma_f32_32x32x16_bf16 v[240:255], v[56:59], v[24:27], v[240:255]
    ds_read_b64_tr_b16 v[44:45], v14 offset:31744
    ds_read_b64_tr_b16 v[46:47], v14 offset:32000
    v_cvt_pk_bf16_f32 v160, v208, v209
    v_cvt_pk_bf16_f32 v161, v210, v211
    v_cvt_pk_bf16_f32 v162, v212, v213
    v_cvt_pk_bf16_f32 v163, v214, v215
    buffer_load_dwordx4 v[92:95], v15, s[40:43], s64 offen offset:3072 sc1
    s_waitcnt lgkmcnt(8)
    v_mfma_f32_32x32x16_bf16 v[240:255], v[60:63], v[28:31], v[240:255]
    s_barrier
    ds_read_b64_tr_b16 v[16:17], v12 offset:32768
    ds_read_b64_tr_b16 v[18:19], v12 offset:33280
    v_cvt_pk_bf16_f32 v164, v216, v217
    v_cvt_pk_bf16_f32 v165, v218, v219
    v_cvt_pk_bf16_f32 v166, v220, v221
    v_cvt_pk_bf16_f32 v167, v222, v223
    s_waitcnt lgkmcnt(8)
    v_mfma_f32_32x32x16_bf16 v[240:255], v[64:67], v[32:35], v[240:255]
    ds_read_b64_tr_b16 v[20:21], v13 offset:32768
    ds_read_b64_tr_b16 v[22:23], v13 offset:33280
    v_cvt_pk_bf16_f32 v168, v224, v225
    v_cvt_pk_bf16_f32 v169, v226, v227
    v_cvt_pk_bf16_f32 v170, v228, v229
    v_cvt_pk_bf16_f32 v171, v230, v231
    buffer_load_dwordx4 v[96:99], v15, s[40:43], s65 offen offset:0 sc1
    s_waitcnt lgkmcnt(8)
    v_mfma_f32_32x32x16_bf16 v[240:255], v[68:71], v[36:39], v[240:255]
    ds_read_b64_tr_b16 v[24:25], v12 offset:34816
    ds_read_b64_tr_b16 v[26:27], v12 offset:35328
    v_cvt_pk_bf16_f32 v172, v232, v233
    v_cvt_pk_bf16_f32 v173, v234, v235
    v_cvt_pk_bf16_f32 v174, v236, v237
    v_cvt_pk_bf16_f32 v175, v238, v239
    s_waitcnt lgkmcnt(8)
    v_mfma_f32_32x32x16_bf16 v[240:255], v[72:75], v[40:43], v[240:255]
    ds_read_b64_tr_b16 v[28:29], v13 offset:34816
    ds_read_b64_tr_b16 v[30:31], v13 offset:35328
    buffer_load_dwordx4 v[100:103], v15, s[40:43], s65 offen offset:1024 sc1
    s_waitcnt lgkmcnt(8)
    v_mfma_f32_32x32x16_bf16 v[240:255], v[76:79], v[44:47], v[240:255]
    ds_read_b64_tr_b16 v[32:33], v12 offset:36864
    ds_read_b64_tr_b16 v[34:35], v12 offset:37376
    s_waitcnt lgkmcnt(8)
    v_mfma_f32_32x32x16_bf16 v[208:223], v[48:51], v[16:19], 0
    ds_read_b64_tr_b16 v[36:37], v13 offset:36864
    ds_read_b64_tr_b16 v[38:39], v13 offset:37376
    buffer_load_dwordx4 v[104:107], v15, s[40:43], s65 offen offset:2048 sc1
    s_waitcnt lgkmcnt(8)
    v_mfma_f32_32x32x16_bf16 v[224:239], v[48:51], v[20:23], 0
    ds_read_b64_tr_b16 v[40:41], v12 offset:38912
    ds_read_b64_tr_b16 v[42:43], v12 offset:39424
    s_waitcnt lgkmcnt(8)
    v_mfma_f32_32x32x16_bf16 v[208:223], v[52:55], v[24:27], v[208:223]
    ds_read_b64_tr_b16 v[44:45], v13 offset:38912
    ds_read_b64_tr_b16 v[46:47], v13 offset:39424
    buffer_load_dwordx4 v[108:111], v15, s[40:43], s65 offen offset:3072 sc1
    s_waitcnt lgkmcnt(8)
    v_mfma_f32_32x32x16_bf16 v[224:239], v[52:55], v[28:31], v[224:239]
    s_barrier
    ds_read_b64_tr_b16 v[16:17], v12 offset:40960
    ds_read_b64_tr_b16 v[18:19], v12 offset:41472
    v_cvt_pk_bf16_f32 v176, v240, v241
    v_cvt_pk_bf16_f32 v177, v242, v243
    v_cvt_pk_bf16_f32 v178, v244, v245
    v_cvt_pk_bf16_f32 v179, v246, v247
    s_waitcnt lgkmcnt(8)
    v_mfma_f32_32x32x16_bf16 v[208:223], v[56:59], v[32:35], v[208:223]
    ds_read_b64_tr_b16 v[20:21], v13 offset:40960
    ds_read_b64_tr_b16 v[22:23], v13 offset:41472
    v_cvt_pk_bf16_f32 v180, v248, v249
    v_cvt_pk_bf16_f32 v181, v250, v251
    v_cvt_pk_bf16_f32 v182, v252, v253
    v_cvt_pk_bf16_f32 v183, v254, v255
    s_waitcnt lgkmcnt(8)
    v_mfma_f32_32x32x16_bf16 v[224:239], v[56:59], v[36:39], v[224:239]
    ds_read_b64_tr_b16 v[24:25], v12 offset:43008
    ds_read_b64_tr_b16 v[26:27], v12 offset:43520
    s_waitcnt lgkmcnt(8)
    v_mfma_f32_32x32x16_bf16 v[208:223], v[60:63], v[40:43], v[208:223]
    ds_read_b64_tr_b16 v[28:29], v13 offset:43008
    ds_read_b64_tr_b16 v[30:31], v13 offset:43520
    s_waitcnt lgkmcnt(8)
    v_mfma_f32_32x32x16_bf16 v[224:239], v[60:63], v[44:47], v[224:239]
    ds_read_b64_tr_b16 v[32:33], v12 offset:45056
    ds_read_b64_tr_b16 v[34:35], v12 offset:45568
    s_waitcnt lgkmcnt(8)
    v_mfma_f32_32x32x16_bf16 v[208:223], v[64:67], v[16:19], v[208:223]
    ds_read_b64_tr_b16 v[36:37], v13 offset:45056
    ds_read_b64_tr_b16 v[38:39], v13 offset:45568
    s_waitcnt lgkmcnt(8)
    v_mfma_f32_32x32x16_bf16 v[224:239], v[64:67], v[20:23], v[224:239]
    ds_read_b64_tr_b16 v[40:41], v12 offset:47104
    ds_read_b64_tr_b16 v[42:43], v12 offset:47616
    s_waitcnt lgkmcnt(8)
    v_mfma_f32_32x32x16_bf16 v[208:223], v[68:71], v[24:27], v[208:223]
    ds_read_b64_tr_b16 v[44:45], v13 offset:47104
    ds_read_b64_tr_b16 v[46:47], v13 offset:47616
    s_waitcnt lgkmcnt(8)
    v_mfma_f32_32x32x16_bf16 v[224:239], v[68:71], v[28:31], v[224:239]
    s_waitcnt lgkmcnt(6)
    v_mfma_f32_32x32x16_bf16 v[208:223], v[72:75], v[32:35], v[208:223]
    s_waitcnt lgkmcnt(4)
    v_mfma_f32_32x32x16_bf16 v[224:239], v[72:75], v[36:39], v[224:239]
    s_waitcnt lgkmcnt(2)
    v_mfma_f32_32x32x16_bf16 v[208:223], v[76:79], v[40:43], v[208:223]
    s_waitcnt lgkmcnt(0)
    v_mfma_f32_32x32x16_bf16 v[224:239], v[76:79], v[44:47], v[224:239]
L_pagain:
    s_waitcnt vmcnt(7)
    v_xor_b32 v80, v2, v80
    v_xor_b32 v81, v3, v81
    v_xor_b32 v82, v4, v82
    v_xor_b32 v83, v5, v83
    v_or_b32 v6, v80, v81
    v_or3_b32 v6, v6, v82, v83
    v_mfma_f32_32x32x16_bf16 v[240:255], v[112:115], v[80:83], 0
    s_waitcnt vmcnt(6)
    v_xor_b32 v84, v2, v84
    v_xor_b32 v85, v3, v85
    v_xor_b32 v86, v4, v86
    v_xor_b32 v87, v5, v87
    v_or3_b32 v6, v6, v84, v85
    v_or3_b32 v6, v6, v86, v87
    v_mfma_f32_32x32x16_bf16 v[240:255], v[116:119], v[84:87], v[240:255]
    s_waitcnt vmcnt(5)
    v_xor_b32 v88, v2, v88
    v_xor_b32 v89, v3, v89
    v_xor_b32 v90, v4, v90
    v_xor_b32 v91, v5, v91
    v_or3_b32 v6, v6, v88, v89
    v_or3_b32 v6, v6, v90, v91
    v_mfma_f32_32x32x16_bf16 v[240:255], v[136:139], v[88:91], v[240:255]
    s_waitcnt vmcnt(4)
    v_xor_b32 v92, v2, v92
    v_xor_b32 v93, v3, v93
    v_xor_b32 v94, v4, v94
    v_xor_b32 v95, v5, v95
    v_or3_b32 v6, v6, v92, v93
    v_or3_b32 v6, v6, v94, v95
    v_cvt_pk_bf16_f32 v184, v208, v209
    v_cvt_pk_bf16_f32 v185, v210, v211
    v_mfma_f32_32x32x16_bf16 v[240:255], v[140:143], v[92:95], v[240:255]
    s_waitcnt vmcnt(3)
    v_xor_b32 v96, v2, v96
    v_xor_b32 v97, v3, v97
    v_xor_b32 v98, v4, v98
    v_xor_b32 v99, v5, v99
    v_or3_b32 v6, v6, v96, v97
    v_or3_b32 v6, v6, v98, v99
    v_cvt_pk_bf16_f32 v186, v212, v213
    v_cvt_pk_bf16_f32 v187, v214, v215
    v_mfma_f32_32x32x16_bf16 v[240:255], v[160:163], v[96:99], v[240:255]
    s_waitcnt vmcnt(2)
    v_xor_b32 v100, v2, v100
    v_xor_b32 v101, v3, v101
    v_xor_b32 v102, v4, v102
    v_xor_b32 v103, v5, v103
    v_or3_b32 v6, v6, v100, v101
    v_or3_b32 v6, v6, v102, v103
    v_cvt_pk_bf16_f32 v188, v216, v217
    v_cvt_pk_bf16_f32 v189, v218, v219
    v_mfma_f32_32x32x16_bf16 v[240:255], v[164:167], v[100:103], v[240:255]
    s_waitcnt vmcnt(1)
    v_xor_b32 v104, v2, v104
    v_xor_b32 v105, v3, v105
    v_xor_b32 v106, v4, v106
    v_xor_b32 v107, v5, v107
    v_or3_b32 v6, v6, v104, v105
    v_or3_b32 v6, v6, v106, v107
    v_cvt_pk_bf16_f32 v190, v220, v221
    v_cvt_pk_bf16_f32 v191, v222, v223
    v_mfma_f32_32x32x16_bf16 v[240:255], v[184:187], v[104:107], v[240:255]
    s_waitcnt vmcnt(0)
    v_xor_b32 v108, v2, v108
    v_xor_b32 v109, v3, v109
    v_xor_b32 v110, v4, v110
    v_xor_b32 v111, v5, v111
    v_or3_b32 v6, v6, v108, v109
    v_or3_b32 v6, v6, v110, v111
    v_and_b32 v6, 0x80008000, v6
    v_cmp_ne_u32 vcc, 0, v6
    v_mfma_f32_32x32x16_bf16 v[240:255], v[188:191], v[108:111], v[240:255]
    s_cbranch_vccnz L_pslow
L_pok:
    v_lshrrev_b32 v2, 15, v2
    v_lshrrev_b32 v3, 15, v3
    v_lshrrev_b32 v4, 15, v4
    v_lshrrev_b32 v5, 15, v5
    v_mfma_f32_32x32x16_bf16 v[208:223], v[120:123], v[80:83], 0
    v_cvt_pk_bf16_f32 v192, v224, v225
    v_cvt_pk_bf16_f32 v193, v226, v227
    v_cvt_pk_bf16_f32 v194, v228, v229
    v_cvt_pk_bf16_f32 v195, v230, v231
    v_mfma_f32_32x32x16_bf16 v[208:223], v[124:127], v[84:87], v[208:223]
    v_cvt_pk_bf16_f32 v196, v232, v233
    v_cvt_pk_bf16_f32 v197, v234, v235
    v_cvt_pk_bf16_f32 v198, v236, v237
    v_cvt_pk_bf16_f32 v199, v238, v239
    v_mfma_f32_32x32x16_bf16 v[208:223], v[144:147], v[88:91], v[208:223]
    v_cvt_pk_bf16_f32 v240, v240, v241
    v_cvt_pk_bf16_f32 v241, v242, v243
    v_cvt_pk_bf16_f32 v242, v244, v245
    v_cvt_pk_bf16_f32 v243, v246, v247
    v_mfma_f32_32x32x16_bf16 v[208:223], v[148:151], v[92:95], v[208:223]
    v_subrev_u32 v14, 65536, v14
    ds_read_b64_tr_b16 v[16:17], v14 offset:0
    ds_read_b64_tr_b16 v[18:19], v14 offset:256
    v_and_or_b32 v240, v240, s100, v2
    v_and_or_b32 v241, v241, s100, v3
    v_and_or_b32 v242, v242, s100, v4
    v_and_or_b32 v243, v243, s100, v5
    buffer_store_dwordx4 v[240:243], v15, s[40:43], s66 offen offset:0 sc1
    v_mfma_f32_32x32x16_bf16 v[208:223], v[168:171], v[96:99], v[208:223]
    ds_read_b64_tr_b16 v[20:21], v14 offset:1024
    ds_read_b64_tr_b16 v[22:23], v14 offset:1280
    v_cvt_pk_bf16_f32 v244, v248, v249
    v_cvt_pk_bf16_f32 v245, v250, v251
    v_cvt_pk_bf16_f32 v246, v252, v253
    v_cvt_pk_bf16_f32 v247, v254, v255
    v_mfma_f32_32x32x16_bf16 v[208:223], v[172:175], v[100:103], v[208:223]
    ds_read_b64_tr_b16 v[24:25], v14 offset:2048
    ds_read_b64_tr_b16 v[26:27], v14 offset:2304
    v_and_or_b32 v244, v244, s100, v2
    v_and_or_b32 v245, v245, s100, v3
    v_and_or_b32 v246, v246, s100, v4
    v_and_or_b32 v247, v247, s100, v5
    buffer_store_dwordx4 v[244:247], v15, s[40:43], s66 offen offset:1024 sc1
    v_mfma_f32_32x32x16_bf16 v[208:223], v[192:195], v[104:107], v[208:223]
    ds_read_b64_tr_b16 v[28:29], v14 offset:3072
    ds_read_b64_tr_b16 v[30:31], v14 offset:3328
    v_mfma_f32_32x32x16_bf16 v[208:223], v[196:199], v[108:111], v[208:223]
    ds_read_b64_tr_b16 v[32:33], v14 offset:4096
    ds_read_b64_tr_b16 v[34:35], v14 offset:4352
    s_waitcnt lgkmcnt(8)
    v_mfma_f32_32x32x16_bf16 v[224:239], v[48:51], v[16:19], 0
    ds_read_b64_tr_b16 v[36:37], v14 offset:5120
    ds_read_b64_tr_b16 v[38:39], v14 offset:5376
    s_waitcnt lgkmcnt(8)
    v_mfma_f32_32x32x16_bf16 v[224:239], v[52:55], v[20:23], v[224:239]
    ds_read_b64_tr_b16 v[40:41], v14 offset:6144
    ds_read_b64_tr_b16 v[42:43], v14 offset:6400
    s_waitcnt lgkmcnt(8)
    v_mfma_f32_32x32x16_bf16 v[224:239], v[56:59], v[24:27], v[224:239]
    ds_read_b64_tr_b16 v[44:45], v14 offset:7168
    ds_read_b64_tr_b16 v[46:47], v14 offset:7424
    v_cvt_pk_bf16_f32 v208, v208, v209
    v_cvt_pk_bf16_f32 v209, v210, v211
    v_cvt_pk_bf16_f32 v210, v212, v213
    v_cvt_pk_bf16_f32 v211, v214, v215
    s_waitcnt lgkmcnt(8)
    v_mfma_f32_32x32x16_bf16 v[224:239], v[60:63], v[28:31], v[224:239]
    v_and_or_b32 v208, v208, s100, v2
    v_and_or_b32 v209, v209, s100, v3
    v_and_or_b32 v210, v210, s100, v4
    v_and_or_b32 v211, v211, s100, v5
    buffer_store_dwordx4 v[208:211], v15, s[40:43], s67 offen offset:0 sc1
    s_waitcnt lgkmcnt(6)
    v_mfma_f32_32x32x16_bf16 v[224:239], v[64:67], v[32:35], v[224:239]
    v_cvt_pk_bf16_f32 v212, v216, v217
    v_cvt_pk_bf16_f32 v213, v218, v219
    v_cvt_pk_bf16_f32 v214, v220, v221
    v_cvt_pk_bf16_f32 v215, v222, v223
    s_waitcnt lgkmcnt(4)
    v_mfma_f32_32x32x16_bf16 v[224:239], v[68:71], v[36:39], v[224:239]
    v_and_or_b32 v212, v212, s100, v2
    v_and_or_b32 v213, v213, s100, v3
    v_and_or_b32 v214, v214, s100, v4
    v_and_or_b32 v215, v215, s100, v5
    buffer_store_dwordx4 v[212:215], v15, s[40:43], s67 offen offset:1024 sc1
    s_waitcnt lgkmcnt(2)
    v_mfma_f32_32x32x16_bf16 v[224:239], v[72:75], v[40:43], v[224:239]
    s_waitcnt lgkmcnt(0)
    v_mfma_f32_32x32x16_bf16 v[224:239], v[76:79], v[44:47], v[224:239]
    v_mfma_f32_32x32x16_bf16 v[240:255], v[128:131], v[80:83], 0
    s_nop 2
    v_mfma_f32_32x32x16_bf16 v[240:255], v[132:135], v[84:87], v[240:255]
    s_nop 2
    v_mfma_f32_32x32x16_bf16 v[240:255], v[152:155], v[88:91], v[240:255]
    s_nop 2
    v_mfma_f32_32x32x16_bf16 v[240:255], v[156:159], v[92:95], v[240:255]
    v_cvt_pk_bf16_f32 v200, v224, v225
    v_cvt_pk_bf16_f32 v201, v226, v227
    v_cvt_pk_bf16_f32 v202, v228, v229
    v_cvt_pk_bf16_f32 v203, v230, v231
    v_mfma_f32_32x32x16_bf16 v[240:255], v[176:179], v[96:99], v[240:255]
    v_cvt_pk_bf16_f32 v204, v232, v233
    v_cvt_pk_bf16_f32 v205, v234, v235
    v_cvt_pk_bf16_f32 v206, v236, v237
    v_cvt_pk_bf16_f32 v207, v238, v239
    s_barrier
    v_mfma_f32_32x32x16_bf16 v[240:255], v[180:183], v[100:103], v[240:255]
    s_nop 1
    v_mfma_f32_32x32x16_bf16 v[240:255], v[200:203], v[104:107], v[240:255]
    v_mfma_f32_32x32x16_bf16 v[240:255], v[204:207], v[108:111], v[240:255]
    s_nop 11
    v_cvt_pk_bf16_f32 v240, v240, v241
    v_cvt_pk_bf16_f32 v241, v242, v243
    v_cvt_pk_bf16_f32 v242, v244, v245
    v_cvt_pk_bf16_f32 v243, v246, v247
    v_and_or_b32 v240, v240, s100, v2
    v_and_or_b32 v241, v241, s100, v3
    v_and_or_b32 v242, v242, s100, v4
    v_and_or_b32 v243, v243, s100, v5
    buffer_store_dwordx4 v[240:243], v15, s[40:43], s68 offen offset:0 sc1
    v_cvt_pk_bf16_f32 v244, v248, v249
    v_cvt_pk_bf16_f32 v245, v250, v251
    v_cvt_pk_bf16_f32 v246, v252, v253
    v_cvt_pk_bf16_f32 v247, v254, v255
    v_and_or_b32 v244, v244, s100, v2
    v_and_or_b32 v245, v245, s100, v3
    v_and_or_b32 v246, v246, s100, v4
    v_and_or_b32 v247, v247, s100, v5
    buffer_store_dwordx4 v[244:247], v15, s[40:43], s68 offen offset:1024 sc1
    s_waitcnt vmcnt(4)
    s_barrier
    s_waitcnt vmcnt(2)
    s_barrier
L_done:
    s_endpgm
L_upd:
    s_lshl2_add_u32 s56, s2, s52
    s_cmp_lg_u32 s56, 1020
    s_cbranch_scc1 L_done
    v_lshrrev_b32 v8, 2, v1
    v_and_b32 v9, 48, v15
    v_lshl_add_u32 v8, v8, 11, v9
    s_mov_b32 s62, 8192
L_uloop:
    s_mov_b32 s56, 0
    buffer_load_dwordx4 v[112:115], v8, s[40:43], s56 offen sc1
    s_mov_b32 s56, 32768
    buffer_load_dwordx4 v[116:119], v8, s[40:43], s56 offen sc1
    s_mov_b32 s56, 131072
    buffer_load_dwordx4 v[120:123], v8, s[40:43], s56 offen sc1
    s_mov_b32 s56, 163840
    buffer_load_dwordx4 v[124:127], v8, s[40:43], s56 offen sc1
    s_mov_b32 s56, 262144
    buffer_load_dwordx4 v[128:131], v8, s[40:43], s56 offen sc1
    s_mov_b32 s56, 294912
    buffer_load_dwordx4 v[132:135], v8, s[40:43], s56 offen sc1
    s_mov_b32 s56, 393216
    buffer_load_dwordx4 v[136:139], v8, s[40:43], s56 offen sc1
    s_mov_b32 s56, 425984
    buffer_load_dwordx4 v[140:143], v8, s[40:43], s56 offen sc1
    s_mov_b32 s56, 524288
    buffer_load_dwordx4 v[144:147], v8, s[40:43], s56 offen sc1
    s_mov_b32 s56, 557056
    buffer_load_dwordx4 v[148:151], v8, s[40:43], s56 offen sc1
    s_mov_b32 s56, 655360
    buffer_load_dwordx4 v[152:155], v8, s[40:43], s56 offen sc1
    s_mov_b32 s56, 688128
    buffer_load_dwordx4 v[156:159], v8, s[40:43], s56 offen sc1
    s_mov_b32 s56, 786432
    buffer_load_dwordx4 v[160:163], v8, s[40:43], s56 offen sc1
    s_mov_b32 s56, 819200
    buffer_load_dwordx4 v[164:167], v8, s[40:43], s56 offen sc1
    s_mov_b32 s56, 917504
    buffer_load_dwordx4 v[168:171], v8, s[40:43], s56 offen sc1
    s_mov_b32 s56, 950272
    buffer_load_dwordx4 v[172:175], v8, s[40:43], s56 offen sc1
    s_waitcnt vmcnt(0)
    v_xor_b32 v112, v2, v112
    v_xor_b32 v113, v3, v113
    v_xor_b32 v114, v4, v114
    v_xor_b32 v115, v5, v115
    v_or_b32 v6, v112, v113
    v_or3_b32 v6, v6, v114, v115
    v_xor_b32 v116, v2, v116
    v_xor_b32 v117, v3, v117
    v_xor_b32 v118, v4, v118
    v_xor_b32 v119, v5, v119
    v_or3_b32 v6, v6, v116, v117
    v_or3_b32 v6, v6, v118, v119
    v_xor_b32 v120, v2, v120
    v_xor_b32 v121, v3, v121
    v_xor_b32 v122, v4, v122
    v_xor_b32 v123, v5, v123
    v_or3_b32 v6, v6, v120, v121
    v_or3_b32 v6, v6, v122, v123
    v_xor_b32 v124, v2, v124
    v_xor_b32 v125, v3, v125
    v_xor_b32 v126, v4, v126
    v_xor_b32 v127, v5, v127
    v_or3_b32 v6, v6, v124, v125
    v_or3_b32 v6, v6, v126, v127
    v_xor_b32 v128, v2, v128
    v_xor_b32 v129, v3, v129
    v_xor_b32 v130, v4, v130
    v_xor_b32 v131, v5, v131
    v_or3_b32 v6, v6, v128, v129
    v_or3_b32 v6, v6, v130, v131
    v_xor_b32 v132, v2, v132
    v_xor_b32 v133, v3, v133
    v_xor_b32 v134, v4, v134
    v_xor_b32 v135, v5, v135
    v_or3_b32 v6, v6, v132, v133
    v_or3_b32 v6, v6, v134, v135
    v_xor_b32 v136, v2, v136
    v_xor_b32 v137, v3, v137
    v_xor_b32 v138, v4, v138
    v_xor_b32 v139, v5, v139
    v_or3_b32 v6, v6, v136, v137
    v_or3_b32 v6, v6, v138, v139
    v_xor_b32 v140, v2, v140
    v_xor_b32 v141, v3, v141
    v_xor_b32 v142, v4, v142
    v_xor_b32 v143, v5, v143
    v_or3_b32 v6, v6, v140, v141
    v_or3_b32 v6, v6, v142, v143
    v_xor_b32 v144, v2, v144
    v_xor_b32 v145, v3, v145
    v_xor_b32 v146, v4, v146
    v_xor_b32 v147, v5, v147
    v_or3_b32 v6, v6, v144, v145
    v_or3_b32 v6, v6, v146, v147
    v_xor_b32 v148, v2, v148
    v_xor_b32 v149, v3, v149
    v_xor_b32 v150, v4, v150
    v_xor_b32 v151, v5, v151
    v_or3_b32 v6, v6, v148, v149
    v_or3_b32 v6, v6, v150, v151
    v_xor_b32 v152, v2, v152
    v_xor_b32 v153, v3, v153
    v_xor_b32 v154, v4, v154
    v_xor_b32 v155, v5, v155
    v_or3_b32 v6, v6, v152, v153
    v_or3_b32 v6, v6, v154, v155
    v_xor_b32 v156, v2, v156
    v_xor_b32 v157, v3, v157
    v_xor_b32 v158, v4, v158
    v_xor_b32 v159, v5, v159
    v_or3_b32 v6, v6, v156, v157
    v_or3_b32 v6, v6, v158, v159
    v_xor_b32 v160, v2, v160
    v_xor_b32 v161, v3, v161
    v_xor_b32 v162, v4, v162
    v_xor_b32 v163, v5, v163
    v_or3_b32 v6, v6, v160, v161
    v_or3_b32 v6, v6, v162, v163
    v_xor_b32 v164, v2, v164
    v_xor_b32 v165, v3, v165
    v_xor_b32 v166, v4, v166
    v_xor_b32 v167, v5, v167
    v_or3_b32 v6, v6, v164, v165
    v_or3_b32 v6, v6, v166, v167
    v_xor_b32 v168, v2, v168
    v_xor_b32 v169, v3, v169
    v_xor_b32 v170, v4, v170
    v_xor_b32 v171, v5, v171
    v_or3_b32 v6, v6, v168, v169
    v_or3_b32 v6, v6, v170, v171
    v_xor_b32 v172, v2, v172
    v_xor_b32 v173, v3, v173
    v_xor_b32 v174, v4, v174
    v_xor_b32 v175, v5, v175
    v_or3_b32 v6, v6, v172, v173
    v_or3_b32 v6, v6, v174, v175
    v_and_b32 v6, 0x80008000, v6
    v_cmp_ne_u32 vcc, 0, v6
    s_sub_u32 s62, s62, 1
    s_cbranch_scc1 L_uout
    s_cbranch_vccnz L_uloop
L_uout:
    s_mov_b64 exec, 1
    buffer_store_dword v7, off, s[40:43], s69 sc1
    s_branch L_done
L_pslow:
    s_sub_u32 s62, s62, 1
    s_cbranch_scc1 L_pok
    buffer_load_dwordx4 v[80:83], v15, s[40:43], s64 offen offset:0 sc1
    buffer_load_dwordx4 v[84:87], v15, s[40:43], s64 offen offset:1024 sc1
    buffer_load_dwordx4 v[88:91], v15, s[40:43], s64 offen offset:2048 sc1
    buffer_load_dwordx4 v[92:95], v15, s[40:43], s64 offen offset:3072 sc1
    buffer_load_dwordx4 v[96:99], v15, s[40:43], s65 offen offset:0 sc1
    buffer_load_dwordx4 v[100:103], v15, s[40:43], s65 offen offset:1024 sc1
    buffer_load_dwordx4 v[104:107], v15, s[40:43], s65 offen offset:2048 sc1
    buffer_load_dwordx4 v[108:111], v15, s[40:43], s65 offen offset:3072 sc1
    s_waitcnt vmcnt(0)
    s_branch L_pagain
L_exit:
    s_endpgm
L_end:
.section .rodata,"a"
.p2align 6
.amdhsa_kernel standalone__gqa_block_cached__near_ridge_kernel
  .amdhsa_next_free_vgpr 256
  .amdhsa_next_free_sgpr 102
  .amdhsa_accum_offset 256
  .amdhsa_group_segment_fixed_size 0
  .amdhsa_kernarg_size 64
  .amdhsa_user_sgpr_count 2
  .amdhsa_user_sgpr_kernarg_segment_ptr 1
  .amdhsa_system_sgpr_workgroup_id_x 1
.end_amdhsa_kernel
```
